```python
import torch

def _softmax(x, axis=-1):
    return torch.softmax(x, dim=axis)

def _gelu(x):
    return torch.nn.functional.gelu(x, approximate='tanh')

def _silu(x):
    return torch.nn.functional.silu(x)

def _sigmoid(x):
    return torch.sigmoid(x)

def _layernorm(x, axis=-1, eps=1e-05):
    m = x.mean(dim=axis, keepdim=True)
    v = x.var(dim=axis, keepdim=True, unbiased=False)
    return (x - m) / torch.sqrt(v + eps)

def _scatter_add(tgt, idx, src, axis=0):
    return tgt.clone().index_add_(axis, idx, src)

def _segment_sum(src, seg, n):
    out = torch.zeros((n,) + src.shape[1:], dtype=src.dtype)
    return out.index_add_(0, seg, src)

def _pad(x, pw):
    flat = tuple((v for pair in reversed(pw) for v in pair))
    return torch.nn.functional.pad(x, flat)
kernel_name = 'adaLN_cond__mha_block_cached__geglu_ffn__decode'

def setup_inputs():

    _w = lambda a: (lambda t: t.to(torch.bfloat16) if t.is_floating_point() else t)(torch.as_tensor(a))

    def _A_setup():
        B, Sq, D = (8, 1, 448)
        H, Sk, Dh = (16, 4096, 256)
        return {'x': _w((lambda *s: torch.randn(*s, dtype=torch.bfloat16) * 0.05)(B, Sq, D)), 'k_cache': _w((lambda *s: torch.randn(*s, dtype=torch.bfloat16) * 3.2)(B, H, Sk, Dh)), 'v_cache': _w((lambda *s: torch.randn(*s, dtype=torch.bfloat16) * 0.4)(B, H, Sk, Dh)), 'wq': _w((lambda *s: torch.randn(*s, dtype=torch.bfloat16) * 3.2)(D, H * Dh) * D ** (-0.5)), 'wo': _w((lambda *s: torch.randn(*s, dtype=torch.bfloat16) * 0.4)(H * Dh, D) * (H * Dh) ** (-0.5))}
    _A_in = _A_setup()

    def _B_setup():
        B, S, D, F = (8, 1, 448, 1792)
        return {'x': _w((lambda *s: torch.randn(*s, dtype=torch.bfloat16) * 0.05)(B, S, D)), 'w_gate': _w((lambda *s: torch.randn(*s, dtype=torch.bfloat16) * 0.05)(D, F)), 'w_up': _w((lambda *s: torch.randn(*s, dtype=torch.bfloat16) * 0.05)(D, F)), 'w_down': _w((lambda *s: torch.randn(*s, dtype=torch.bfloat16) * 0.05)(F, D))}
    _B_in = _B_setup()
    return {'A_x': _A_in['x'], 'A_k_cache': _A_in['k_cache'], 'A_v_cache': _A_in['v_cache'], 'A_wq': _A_in['wq'], 'A_wo': _A_in['wo'], 'B_x': _B_in['x'], 'B_w_gate': _B_in['w_gate'], 'B_w_up': _B_in['w_up'], 'B_w_down': _B_in['w_down'], 'c': _w((lambda *s: torch.randn(*s, dtype=torch.bfloat16) * 0.2)(8, 448) * 8.0), 'w_mod': _w((lambda *s: torch.randn(*s, dtype=torch.bfloat16) * 0.2)(448, 6 * 448) * 448 ** (-0.5) * 8.0)}

def reference(A_x, A_k_cache, A_v_cache, A_wq, A_wo, B_x, B_w_gate, B_w_up, B_w_down, c, w_mod):

    def _A_ref(x, k_cache, v_cache, wq, wo):
        B, Sq, D = x.shape
        H, Dh = (16, 256)
        q = (lambda x, *d: x.permute(*d))((x @ wq).reshape(B, Sq, H, Dh), 0, 2, 1, 3)
        scores = torch.einsum('bhqd,bhkd->bhqk', q, k_cache) * Dh ** (-0.5)
        p = _softmax(scores, axis=-1)
        o = torch.einsum('bhqk,bhkd->bhqd', p, v_cache)
        return (lambda x, *d: x.permute(*d))(o, 0, 2, 1, 3).reshape(B, Sq, H * Dh) @ wo

    def _B_ref(x, w_gate, w_up, w_down):
        return _gelu(x @ w_gate) * (x @ w_up) @ w_down
    x = A_x
    mod = (_silu(c) @ w_mod).reshape(c.shape[0], 6, 1, -1)
    sa, ca, ga, sb, cb, gb = (mod[:, 0].clone(), mod[:, 1].clone(), mod[:, 2].clone(), mod[:, 3].clone(), mod[:, 4].clone(), mod[:, 5].clone())
    h = _layernorm(x, axis=-1) * (1 + ca) + sa
    x = x + ga * _A_ref(h, A_k_cache, A_v_cache, A_wq, A_wo)
    h = _layernorm(x, axis=-1) * (1 + cb) + sb
    x = x + gb * _B_ref(h, B_w_gate, B_w_up, B_w_down)
    return x
```

```asm
; @launch grid=(256,1,1) block=(512,1,1) lds=163840
.amdgcn_target "amdgcn-amd-amdhsa--gfx950"
.text
.globl adaLN_cond__mha_block_cached__geglu_ffn__decode_kernel
.p2align 8
.type adaLN_cond__mha_block_cached__geglu_ffn__decode_kernel,@function
adaLN_cond__mha_block_cached__geglu_ffn__decode_kernel:
    s_cmp_ge_u32 s2, 256
    s_cbranch_scc1 L_end
    s_load_dwordx16 s[4:19], s[0:1], 0
    s_load_dwordx8 s[20:27], s[0:1], 64
    s_load_dwordx4 s[28:31], s[0:1], 96
    v_lshrrev_b32 v1, 6, v0
    s_nop 0
    v_readfirstlane_b32 s3, v1
    v_and_b32 v1, 63, v0
    s_cmp_lg_u32 s3, 4
    s_cbranch_scc1 L_noz
    v_lshlrev_b32 v2, 2, v1
    v_mov_b32 v3, 0
    s_mov_b64 exec, 0xffff
    ds_write_b32 v2, v3 offset:0
    ds_write_b32 v2, v3 offset:1728
    s_mov_b32 exec_lo, -1
    ds_write_b32 v2, v3 offset:15104
    s_mov_b64 exec, -1
L_noz:
    s_mov_b32 s62, 0x05040100
    s_mov_b32 s63, 0x07060302
    s_mov_b32 s52, 0xffff0000
    s_mov_b32 s53, 0xffff0000
    s_lshr_b32 s33, s2, 5
    s_waitcnt lgkmcnt(0)
    s_and_b32 s54, s2, 1
    s_bfe_u32 s55, s2, 0x20001
    s_xor_b32 s55, s55, s54
    s_lshl_b32 s55, s55, 1
    s_add_u32 s55, s55, s54
    s_and_b32 s14, s2, 0xf8
    s_add_u32 s14, s14, s55
    s_lshr_b32 s34, s14, 1
    s_and_b32 s34, s34, 15
    s_lshr_b32 s15, s2, 1
    s_bitcmp1_b32 s2, 0
    s_cselect_b32 s15, 255, s15
    s_load_dword s32, s[30:31], 0
    s_mov_b32 s36, s30
    s_mov_b32 s37, s31
    s_mov_b32 s38, 0x1000000
    s_mov_b32 s39, 0x00020000
    s_barrier
    s_cmp_ge_u32 s3, 4
    s_cbranch_scc1 L_helper
    s_mov_b32 s35, s3
    s_mov_b32 s40, s6
    s_mov_b32 s41, s7
    s_mov_b32 s42, 0x10000000
    s_mov_b32 s43, 0x00020000
    s_mov_b32 s44, s8
    s_mov_b32 s45, s9
    s_mov_b32 s46, 0x10000000
    s_mov_b32 s47, 0x00020000
    s_lshr_b32 s50, s14, 1
    s_lshl_b32 s50, s50, 21
    s_lshl_b32 s54, s3, 13
    s_add_u32 s50, s50, s54
    s_lshr_b32 s100, s14, 1
    s_lshl_b32 s100, s100, 21
    s_add_u32 s100, s100, 786432
    s_and_b32 s54, s14, 1
    s_mul_i32 s57, s54, 1310720
    s_add_u32 s57, s57, s50
    s_mov_b32 s98, s57
    s_add_u32 s99, s98, 4096
    v_lshlrev_b32 v2, 4, v1
    s_cmp_ge_u32 s15, 14
    s_cbranch_scc1 L_go
    v_mov_b32 v44, 32
    s_mov_b32 s96, 0
Lw_1:
    ds_read_b32 v45, v44
    s_waitcnt lgkmcnt(0)
    v_readfirstlane_b32 s54, v45
    s_cmp_ge_u32 s54, 4
    s_cbranch_scc1 Lwd_2
    s_add_u32 s96, s96, 1
    s_cmp_ge_u32 s96, 0x8000
    s_cbranch_scc1 Lwd_2
    s_sleep 1
    s_branch Lw_1
Lwd_2:
L_go:
    s_lshl_b32 s55, s3, 15
    s_add_u32 s55, s55, 32768
    s_mov_b32 s58, 4
    buffer_load_dwordx4 v[112:115], v2, s[40:43], s98 offen offset:0 nt
    buffer_load_dwordx4 v[116:119], v2, s[40:43], s98 offen offset:1024 nt
    buffer_load_dwordx4 v[120:123], v2, s[40:43], s98 offen offset:2048 nt
    buffer_load_dwordx4 v[124:127], v2, s[40:43], s98 offen offset:3072 nt
    buffer_load_dwordx4 v[128:131], v2, s[40:43], s99 offen offset:0 nt
    buffer_load_dwordx4 v[132:135], v2, s[40:43], s99 offen offset:1024 nt
    buffer_load_dwordx4 v[136:139], v2, s[40:43], s99 offen offset:2048 nt
    buffer_load_dwordx4 v[140:143], v2, s[40:43], s99 offen offset:3072 nt
    buffer_load_dwordx4 v[144:147], v2, s[44:47], s98 offen offset:0 nt
    buffer_load_dwordx4 v[148:151], v2, s[44:47], s98 offen offset:1024 nt
    buffer_load_dwordx4 v[152:155], v2, s[44:47], s98 offen offset:2048 nt
    buffer_load_dwordx4 v[156:159], v2, s[44:47], s98 offen offset:3072 nt
    s_waitcnt vmcnt(11)
    buffer_load_dwordx4 v[160:163], v2, s[44:47], s99 offen offset:0 nt
    s_waitcnt vmcnt(11)
    buffer_load_dwordx4 v[164:167], v2, s[44:47], s99 offen offset:1024 nt
    s_waitcnt vmcnt(11)
    buffer_load_dwordx4 v[168:171], v2, s[44:47], s99 offen offset:2048 nt
    s_waitcnt vmcnt(11)
    buffer_load_dwordx4 v[172:175], v2, s[44:47], s99 offen offset:3072 nt
    s_add_u32 s98, s98, 32768
    s_add_u32 s99, s99, 32768
    s_waitcnt vmcnt(11)
    buffer_load_dwordx4 v[176:179], v2, s[40:43], s98 offen offset:0 nt
    s_waitcnt vmcnt(11)
    buffer_load_dwordx4 v[180:183], v2, s[40:43], s98 offen offset:1024 nt
    s_waitcnt vmcnt(11)
    buffer_load_dwordx4 v[184:187], v2, s[40:43], s98 offen offset:2048 nt
    s_waitcnt vmcnt(11)
    buffer_load_dwordx4 v[188:191], v2, s[40:43], s98 offen offset:3072 nt
    s_waitcnt vmcnt(11)
    buffer_load_dwordx4 v[192:195], v2, s[40:43], s99 offen offset:0 nt
    s_waitcnt vmcnt(11)
    buffer_load_dwordx4 v[196:199], v2, s[40:43], s99 offen offset:1024 nt
    s_waitcnt vmcnt(11)
    buffer_load_dwordx4 v[200:203], v2, s[40:43], s99 offen offset:2048 nt
    s_waitcnt vmcnt(11)
    buffer_load_dwordx4 v[204:207], v2, s[40:43], s99 offen offset:3072 nt
    s_waitcnt vmcnt(11)
    buffer_load_dwordx4 v[208:211], v2, s[44:47], s98 offen offset:0 nt
    s_waitcnt vmcnt(11)
    buffer_load_dwordx4 v[212:215], v2, s[44:47], s98 offen offset:1024 nt
    s_waitcnt vmcnt(11)
    buffer_load_dwordx4 v[216:219], v2, s[44:47], s98 offen offset:2048 nt
    s_waitcnt vmcnt(11)
    buffer_load_dwordx4 v[220:223], v2, s[44:47], s98 offen offset:3072 nt
    s_waitcnt vmcnt(11)
    buffer_load_dwordx4 v[224:227], v2, s[44:47], s99 offen offset:0 nt
    s_waitcnt vmcnt(11)
    buffer_load_dwordx4 v[228:231], v2, s[44:47], s99 offen offset:1024 nt
    s_waitcnt vmcnt(11)
    buffer_load_dwordx4 v[232:235], v2, s[44:47], s99 offen offset:2048 nt
    s_waitcnt vmcnt(11)
    buffer_load_dwordx4 v[236:239], v2, s[44:47], s99 offen offset:3072 nt
    s_add_u32 s98, s98, 32768
    s_add_u32 s99, s99, 32768
    v_mov_b32 v44, 0
    ds_read_b32 v45, v44
    s_waitcnt lgkmcnt(0)
    v_readfirstlane_b32 s54, v45
    s_mov_b32 s58, 2
    s_cmp_lg_u32 s54, 0
    s_cbranch_scc1 L_ring0
    s_waitcnt vmcnt(11)
    s_add_u32 m0, s55, 0
    s_nop 0
    buffer_load_dwordx4 v2, s[40:43], s98 offen offset:0 nt lds
    s_waitcnt vmcnt(11)
    buffer_load_dwordx4 v2, s[40:43], s98 offen offset:1024 nt lds
    s_waitcnt vmcnt(11)
    buffer_load_dwordx4 v2, s[40:43], s98 offen offset:2048 nt lds
    s_waitcnt vmcnt(11)
    buffer_load_dwordx4 v2, s[40:43], s98 offen offset:3072 nt lds
    s_waitcnt vmcnt(11)
    s_add_u32 m0, s55, 4096
    s_nop 0
    buffer_load_dwordx4 v2, s[40:43], s99 offen offset:0 nt lds
    s_waitcnt vmcnt(11)
    buffer_load_dwordx4 v2, s[40:43], s99 offen offset:1024 nt lds
    s_waitcnt vmcnt(11)
    buffer_load_dwordx4 v2, s[40:43], s99 offen offset:2048 nt lds
    s_waitcnt vmcnt(11)
    buffer_load_dwordx4 v2, s[40:43], s99 offen offset:3072 nt lds
    s_waitcnt vmcnt(11)
    s_add_u32 m0, s55, 8192
    s_nop 0
    buffer_load_dwordx4 v2, s[44:47], s98 offen offset:0 nt lds
    s_waitcnt vmcnt(11)
    buffer_load_dwordx4 v2, s[44:47], s98 offen offset:1024 nt lds
    s_waitcnt vmcnt(11)
    buffer_load_dwordx4 v2, s[44:47], s98 offen offset:2048 nt lds
    s_waitcnt vmcnt(11)
    buffer_load_dwordx4 v2, s[44:47], s98 offen offset:3072 nt lds
    s_waitcnt vmcnt(11)
    s_add_u32 m0, s55, 12288
    s_nop 0
    buffer_load_dwordx4 v2, s[44:47], s99 offen offset:0 nt lds
    s_waitcnt vmcnt(11)
    buffer_load_dwordx4 v2, s[44:47], s99 offen offset:1024 nt lds
    s_waitcnt vmcnt(11)
    buffer_load_dwordx4 v2, s[44:47], s99 offen offset:2048 nt lds
    s_waitcnt vmcnt(11)
    buffer_load_dwordx4 v2, s[44:47], s99 offen offset:3072 nt lds
    s_add_u32 s98, s98, 32768
    s_add_u32 s99, s99, 32768
    v_mov_b32 v44, 0
    ds_read_b32 v45, v44
    s_waitcnt lgkmcnt(0)
    v_readfirstlane_b32 s54, v45
    s_mov_b32 s58, 3
    s_cmp_lg_u32 s54, 0
    s_cbranch_scc1 L_ring0
    s_waitcnt vmcnt(11)
    s_add_u32 m0, s55, 16384
    s_nop 0
    buffer_load_dwordx4 v2, s[40:43], s98 offen offset:0 nt lds
    s_waitcnt vmcnt(11)
    buffer_load_dwordx4 v2, s[40:43], s98 offen offset:1024 nt lds
    s_waitcnt vmcnt(11)
    buffer_load_dwordx4 v2, s[40:43], s98 offen offset:2048 nt lds
    s_waitcnt vmcnt(11)
    buffer_load_dwordx4 v2, s[40:43], s98 offen offset:3072 nt lds
    s_waitcnt vmcnt(11)
    s_add_u32 m0, s55, 20480
    s_nop 0
    buffer_load_dwordx4 v2, s[40:43], s99 offen offset:0 nt lds
    s_waitcnt vmcnt(11)
    buffer_load_dwordx4 v2, s[40:43], s99 offen offset:1024 nt lds
    s_waitcnt vmcnt(11)
    buffer_load_dwordx4 v2, s[40:43], s99 offen offset:2048 nt lds
    s_waitcnt vmcnt(11)
    buffer_load_dwordx4 v2, s[40:43], s99 offen offset:3072 nt lds
    s_waitcnt vmcnt(11)
    s_add_u32 m0, s55, 24576
    s_nop 0
    buffer_load_dwordx4 v2, s[44:47], s98 offen offset:0 nt lds
    s_waitcnt vmcnt(11)
    buffer_load_dwordx4 v2, s[44:47], s98 offen offset:1024 nt lds
    s_waitcnt vmcnt(11)
    buffer_load_dwordx4 v2, s[44:47], s98 offen offset:2048 nt lds
    s_waitcnt vmcnt(11)
    buffer_load_dwordx4 v2, s[44:47], s98 offen offset:3072 nt lds
    s_waitcnt vmcnt(11)
    s_add_u32 m0, s55, 28672
    s_nop 0
    buffer_load_dwordx4 v2, s[44:47], s99 offen offset:0 nt lds
    s_waitcnt vmcnt(11)
    buffer_load_dwordx4 v2, s[44:47], s99 offen offset:1024 nt lds
    s_waitcnt vmcnt(11)
    buffer_load_dwordx4 v2, s[44:47], s99 offen offset:2048 nt lds
    s_waitcnt vmcnt(11)
    buffer_load_dwordx4 v2, s[44:47], s99 offen offset:3072 nt lds
    s_add_u32 s98, s98, 32768
    s_add_u32 s99, s99, 32768
    s_mov_b32 s58, 4
L_ring0:
    s_lshl_b32 s54, s58, 15
    s_add_u32 s98, s57, s54
    s_add_u32 s99, s98, 4096
    s_mov_b32 s48, s98
    s_mov_b32 s49, s99
    s_waitcnt vmcnt(11)
    buffer_load_dwordx4 v[48:51], v2, s[40:43], s98 offen offset:0 nt
    s_waitcnt vmcnt(11)
    buffer_load_dwordx4 v[52:55], v2, s[40:43], s98 offen offset:1024 nt
    s_waitcnt vmcnt(11)
    buffer_load_dwordx4 v[56:59], v2, s[40:43], s98 offen offset:2048 nt
    s_waitcnt vmcnt(11)
    buffer_load_dwordx4 v[60:63], v2, s[40:43], s98 offen offset:3072 nt
    s_waitcnt vmcnt(11)
    buffer_load_dwordx4 v[64:67], v2, s[40:43], s99 offen offset:0 nt
    s_waitcnt vmcnt(11)
    buffer_load_dwordx4 v[68:71], v2, s[40:43], s99 offen offset:1024 nt
    s_waitcnt vmcnt(11)
    buffer_load_dwordx4 v[72:75], v2, s[40:43], s99 offen offset:2048 nt
    s_waitcnt vmcnt(11)
    buffer_load_dwordx4 v[76:79], v2, s[40:43], s99 offen offset:3072 nt
    s_waitcnt vmcnt(11)
    buffer_load_dwordx4 v[80:83], v2, s[44:47], s98 offen offset:0 nt
    s_waitcnt vmcnt(11)
    buffer_load_dwordx4 v[84:87], v2, s[44:47], s98 offen offset:1024 nt
    s_waitcnt vmcnt(11)
    buffer_load_dwordx4 v[88:91], v2, s[44:47], s98 offen offset:2048 nt
    s_waitcnt vmcnt(11)
    buffer_load_dwordx4 v[92:95], v2, s[44:47], s98 offen offset:3072 nt
    s_waitcnt vmcnt(11)
    buffer_load_dwordx4 v[96:99], v2, s[44:47], s99 offen offset:0 nt
    s_waitcnt vmcnt(11)
    buffer_load_dwordx4 v[100:103], v2, s[44:47], s99 offen offset:1024 nt
    s_waitcnt vmcnt(11)
    buffer_load_dwordx4 v[104:107], v2, s[44:47], s99 offen offset:2048 nt
    s_waitcnt vmcnt(11)
    buffer_load_dwordx4 v[108:111], v2, s[44:47], s99 offen offset:3072 nt
    s_add_u32 s98, s98, 32768
    s_add_u32 s99, s99, 32768
    v_mov_b32 v8, 0
    v_mov_b32 v9, 0
    v_mov_b32 v10, 0
    v_mov_b32 v11, 0
    v_mov_b32 v12, 0
    v_mov_b32 v13, 0
    v_mov_b32 v14, 0
    v_mov_b32 v15, 0
    v_mov_b32 v16, 0
    v_mov_b32 v17, 0xf149f2ca
    s_mov_b32 s97, 0x3db8aa3b
    v_mov_b32 v44, 0
    s_mov_b32 s96, 0
Lw_3:
    ds_read_b32 v45, v44
    s_waitcnt lgkmcnt(0)
    v_readfirstlane_b32 s54, v45
    s_cmp_ge_u32 s54, 1
    s_cbranch_scc1 Lwd_4
    s_add_u32 s96, s96, 1
    s_cmp_ge_u32 s96, 0x8000
    s_cbranch_scc1 Lwd_4
    s_sleep 1
    s_branch Lw_3
Lwd_4:
    s_mul_i32 s32, s32, 1664525
    s_add_u32 s32, s32, 1013904223
    v_and_b32 v44, 31, v1
    v_lshlrev_b32 v44, 4, v44
    ds_read_b128 v[4:7], v44 offset:128
    s_waitcnt lgkmcnt(0)
    s_mov_b32 s12, 0x7f800000
    s_mov_b32 s13, 0x7f800000
    s_mov_b32 s101, 0
    s_mov_b32 s51, s58
L_loop:
    s_lshl_b32 s54, s3, 2
    s_add_u32 s54, s54, 48
    v_mov_b32 v44, s54
    v_mov_b32 v45, s51
    s_mov_b64 exec, 1
    ds_write_b32 v44, v45
    s_mov_b64 exec, -1
    s_add_u32 s59, s51, 1
    s_cmp_ge_u32 s59, 24
    s_cbranch_scc1 L_dyn
    s_lshl_b32 s54, s59, 15
    s_add_u32 s98, s57, s54
    s_add_u32 s99, s98, 4096
L_gotoff:
    s_waitcnt vmcnt(15)
    v_dot2_f32_bf16 v20, v48, v4, 0
    v_dot2_f32_bf16 v20, v49, v5, v20
    v_dot2_f32_bf16 v20, v50, v6, v20
    v_dot2_f32_bf16 v20, v51, v7, v20
    buffer_load_dwordx4 v[48:51], v2, s[40:43], s98 offen offset:0 nt
    s_waitcnt vmcnt(15)
    v_dot2_f32_bf16 v21, v52, v4, 0
    v_dot2_f32_bf16 v21, v53, v5, v21
    v_dot2_f32_bf16 v21, v54, v6, v21
    v_dot2_f32_bf16 v21, v55, v7, v21
    buffer_load_dwordx4 v[52:55], v2, s[40:43], s98 offen offset:1024 nt
    s_waitcnt vmcnt(15)
    v_dot2_f32_bf16 v22, v56, v4, 0
    v_dot2_f32_bf16 v22, v57, v5, v22
    v_dot2_f32_bf16 v22, v58, v6, v22
    v_dot2_f32_bf16 v22, v59, v7, v22
    buffer_load_dwordx4 v[56:59], v2, s[40:43], s98 offen offset:2048 nt
    s_waitcnt vmcnt(15)
    v_dot2_f32_bf16 v23, v60, v4, 0
    v_dot2_f32_bf16 v23, v61, v5, v23
    v_dot2_f32_bf16 v23, v62, v6, v23
    v_dot2_f32_bf16 v23, v63, v7, v23
    buffer_load_dwordx4 v[60:63], v2, s[40:43], s98 offen offset:3072 nt
    s_waitcnt vmcnt(15)
    v_dot2_f32_bf16 v24, v64, v4, 0
    v_dot2_f32_bf16 v24, v65, v5, v24
    v_dot2_f32_bf16 v24, v66, v6, v24
    v_dot2_f32_bf16 v24, v67, v7, v24
    buffer_load_dwordx4 v[64:67], v2, s[40:43], s99 offen offset:0 nt
    s_waitcnt vmcnt(15)
    v_dot2_f32_bf16 v25, v68, v4, 0
    v_dot2_f32_bf16 v25, v69, v5, v25
    v_dot2_f32_bf16 v25, v70, v6, v25
    v_dot2_f32_bf16 v25, v71, v7, v25
    buffer_load_dwordx4 v[68:71], v2, s[40:43], s99 offen offset:1024 nt
    s_waitcnt vmcnt(15)
    v_dot2_f32_bf16 v26, v72, v4, 0
    v_dot2_f32_bf16 v26, v73, v5, v26
    v_dot2_f32_bf16 v26, v74, v6, v26
    v_dot2_f32_bf16 v26, v75, v7, v26
    buffer_load_dwordx4 v[72:75], v2, s[40:43], s99 offen offset:2048 nt
    s_waitcnt vmcnt(15)
    v_dot2_f32_bf16 v27, v76, v4, 0
    v_dot2_f32_bf16 v27, v77, v5, v27
    v_dot2_f32_bf16 v27, v78, v6, v27
    v_dot2_f32_bf16 v27, v79, v7, v27
    buffer_load_dwordx4 v[76:79], v2, s[40:43], s99 offen offset:3072 nt
    v_permlane16_swap_b32 v20, v21
    v_permlane16_swap_b32 v22, v23
    v_permlane16_swap_b32 v24, v25
    v_permlane16_swap_b32 v26, v27
    v_add_f32 v20, v20, v21
    v_add_f32 v22, v22, v23
    v_add_f32 v24, v24, v25
    v_add_f32 v26, v26, v27
    v_add_f32_dpp v20, v20, v20 row_ror:8 row_mask:0xf bank_mask:0xf
    v_add_f32_dpp v22, v22, v22 row_ror:8 row_mask:0xf bank_mask:0xf
    v_add_f32_dpp v24, v24, v24 row_ror:8 row_mask:0xf bank_mask:0xf
    v_add_f32_dpp v26, v26, v26 row_ror:8 row_mask:0xf bank_mask:0xf
    v_add_f32_dpp v20, v20, v20 row_ror:4 row_mask:0xf bank_mask:0xf
    v_add_f32_dpp v22, v22, v22 row_ror:4 row_mask:0xf bank_mask:0xf
    v_add_f32_dpp v24, v24, v24 row_ror:4 row_mask:0xf bank_mask:0xf
    v_add_f32_dpp v26, v26, v26 row_ror:4 row_mask:0xf bank_mask:0xf
    v_add_f32_dpp v20, v20, v20 row_ror:2 row_mask:0xf bank_mask:0xf
    v_add_f32_dpp v22, v22, v22 row_ror:2 row_mask:0xf bank_mask:0xf
    v_add_f32_dpp v24, v24, v24 row_ror:2 row_mask:0xf bank_mask:0xf
    v_add_f32_dpp v26, v26, v26 row_ror:2 row_mask:0xf bank_mask:0xf
    v_add_f32_dpp v20, v20, v20 row_ror:1 row_mask:0xf bank_mask:0xf
    v_add_f32_dpp v22, v22, v22 row_ror:1 row_mask:0xf bank_mask:0xf
    v_add_f32_dpp v24, v24, v24 row_ror:1 row_mask:0xf bank_mask:0xf
    v_add_f32_dpp v26, v26, v26 row_ror:1 row_mask:0xf bank_mask:0xf
    v_cvt_pk_bf16_f32 v44, v20, v22
    v_lshlrev_b32 v20, 16, v44
    v_and_b32 v22, 0xffff0000, v44
    v_cvt_pk_bf16_f32 v45, v24, v26
    v_lshlrev_b32 v24, 16, v45
    v_and_b32 v26, 0xffff0000, v45
    v_max3_f32 v19, v20, v22, v24
    v_max_f32 v19, v19, v26
    v_mov_b32 v44, v19
    s_nop 1
    v_permlane16_swap_b32 v19, v44
    v_max_f32 v19, v19, v44
    v_mov_b32 v44, v19
    s_nop 1
    v_permlane32_swap_b32 v19, v44
    v_max_f32 v19, v19, v44
    v_mul_f32 v19, s97, v19
    v_max_f32 v19, v19, v17
    v_sub_f32 v18, v17, v19
    v_mov_b32 v17, v19
    v_exp_f32 v18, v18
    v_fma_f32 v20, v20, s97, -v17
    v_fma_f32 v22, v22, s97, -v17
    v_fma_f32 v24, v24, s97, -v17
    v_fma_f32 v26, v26, s97, -v17
    v_exp_f32 v20, v20
    v_exp_f32 v22, v22
    v_exp_f32 v24, v24
    v_exp_f32 v26, v26
    v_add_f32 v44, v20, v22
    v_add_f32 v45, v24, v26
    v_add_f32 v44, v44, v45
    v_fma_f32 v16, v16, v18, v44
    v_mul_f32 v8, v8, v18
    v_mul_f32 v9, v9, v18
    v_mul_f32 v10, v10, v18
    v_mul_f32 v11, v11, v18
    v_mul_f32 v12, v12, v18
    v_mul_f32 v13, v13, v18
    v_mul_f32 v14, v14, v18
    v_mul_f32 v15, v15, v18
    v_cvt_pk_bf16_f32 v28, v20, 0
    v_cvt_pk_bf16_f32 v30, v22, 0
    v_cvt_pk_bf16_f32 v32, v24, 0
    v_cvt_pk_bf16_f32 v34, v26, 0
    v_mov_b32 v29, v28
    v_mov_b32 v31, v30
    v_mov_b32 v33, v32
    v_mov_b32 v35, v34
    v_permlane16_swap_b32 v28, v29
    v_permlane16_swap_b32 v30, v31
    v_permlane16_swap_b32 v32, v33
    v_permlane16_swap_b32 v34, v35
    v_lshlrev_b32 v36, 16, v28
    v_lshlrev_b32 v37, 16, v29
    v_lshlrev_b32 v38, 16, v30
    v_lshlrev_b32 v39, 16, v31
    v_lshlrev_b32 v40, 16, v32
    v_lshlrev_b32 v41, 16, v33
    v_lshlrev_b32 v42, 16, v34
    v_lshlrev_b32 v43, 16, v35
    s_waitcnt vmcnt(15)
    v_dot2c_f32_bf16 v8, v80, v28
    v_dot2c_f32_bf16 v9, v80, v36
    v_dot2c_f32_bf16 v10, v81, v28
    v_dot2c_f32_bf16 v11, v81, v36
    v_dot2c_f32_bf16 v12, v82, v28
    v_dot2c_f32_bf16 v13, v82, v36
    v_dot2c_f32_bf16 v14, v83, v28
    v_dot2c_f32_bf16 v15, v83, v36
    buffer_load_dwordx4 v[80:83], v2, s[44:47], s98 offen offset:0 nt
    s_waitcnt vmcnt(15)
    v_dot2c_f32_bf16 v8, v84, v29
    v_dot2c_f32_bf16 v9, v84, v37
    v_dot2c_f32_bf16 v10, v85, v29
    v_dot2c_f32_bf16 v11, v85, v37
    v_dot2c_f32_bf16 v12, v86, v29
    v_dot2c_f32_bf16 v13, v86, v37
    v_dot2c_f32_bf16 v14, v87, v29
    v_dot2c_f32_bf16 v15, v87, v37
    buffer_load_dwordx4 v[84:87], v2, s[44:47], s98 offen offset:1024 nt
    s_waitcnt vmcnt(15)
    v_dot2c_f32_bf16 v8, v88, v30
    v_dot2c_f32_bf16 v9, v88, v38
    v_dot2c_f32_bf16 v10, v89, v30
    v_dot2c_f32_bf16 v11, v89, v38
    v_dot2c_f32_bf16 v12, v90, v30
    v_dot2c_f32_bf16 v13, v90, v38
    v_dot2c_f32_bf16 v14, v91, v30
    v_dot2c_f32_bf16 v15, v91, v38
    buffer_load_dwordx4 v[88:91], v2, s[44:47], s98 offen offset:2048 nt
    s_waitcnt vmcnt(15)
    v_dot2c_f32_bf16 v8, v92, v31
    v_dot2c_f32_bf16 v9, v92, v39
    v_dot2c_f32_bf16 v10, v93, v31
    v_dot2c_f32_bf16 v11, v93, v39
    v_dot2c_f32_bf16 v12, v94, v31
    v_dot2c_f32_bf16 v13, v94, v39
    v_dot2c_f32_bf16 v14, v95, v31
    v_dot2c_f32_bf16 v15, v95, v39
    buffer_load_dwordx4 v[92:95], v2, s[44:47], s98 offen offset:3072 nt
    s_waitcnt vmcnt(15)
    v_dot2c_f32_bf16 v8, v96, v32
    v_dot2c_f32_bf16 v9, v96, v40
    v_dot2c_f32_bf16 v10, v97, v32
    v_dot2c_f32_bf16 v11, v97, v40
    v_dot2c_f32_bf16 v12, v98, v32
    v_dot2c_f32_bf16 v13, v98, v40
    v_dot2c_f32_bf16 v14, v99, v32
    v_dot2c_f32_bf16 v15, v99, v40
    buffer_load_dwordx4 v[96:99], v2, s[44:47], s99 offen offset:0 nt
    s_waitcnt vmcnt(15)
    v_dot2c_f32_bf16 v8, v100, v33
    v_dot2c_f32_bf16 v9, v100, v41
    v_dot2c_f32_bf16 v10, v101, v33
    v_dot2c_f32_bf16 v11, v101, v41
    v_dot2c_f32_bf16 v12, v102, v33
    v_dot2c_f32_bf16 v13, v102, v41
    v_dot2c_f32_bf16 v14, v103, v33
    v_dot2c_f32_bf16 v15, v103, v41
    buffer_load_dwordx4 v[100:103], v2, s[44:47], s99 offen offset:1024 nt
    s_waitcnt vmcnt(15)
    v_dot2c_f32_bf16 v8, v104, v34
    v_dot2c_f32_bf16 v9, v104, v42
    v_dot2c_f32_bf16 v10, v105, v34
    v_dot2c_f32_bf16 v11, v105, v42
    v_dot2c_f32_bf16 v12, v106, v34
    v_dot2c_f32_bf16 v13, v106, v42
    v_dot2c_f32_bf16 v14, v107, v34
    v_dot2c_f32_bf16 v15, v107, v42
    buffer_load_dwordx4 v[104:107], v2, s[44:47], s99 offen offset:2048 nt
    s_waitcnt vmcnt(15)
    v_dot2c_f32_bf16 v8, v108, v35
    v_dot2c_f32_bf16 v9, v108, v43
    v_dot2c_f32_bf16 v10, v109, v35
    v_dot2c_f32_bf16 v11, v109, v43
    v_dot2c_f32_bf16 v12, v110, v35
    v_dot2c_f32_bf16 v13, v110, v43
    v_dot2c_f32_bf16 v14, v111, v35
    v_dot2c_f32_bf16 v15, v111, v43
    buffer_load_dwordx4 v[108:111], v2, s[44:47], s99 offen offset:3072 nt
    s_mov_b32 s12, s13
    s_mov_b32 s48, s98
    s_mov_b32 s49, s99
    s_cmp_lt_u32 s101, s58
    s_cbranch_scc1 L_pcons
L_back:
    s_add_u32 s51, s51, 1
    s_branch L_loop
L_dyn:
    s_sub_u32 s59, s59, 23
    s_sub_u32 s54, s59, 1
    s_and_b32 s54, s54, 7
    s_lshl_b32 s54, s54, 2
    s_lshl_b32 s55, s3, 5
    s_add_u32 s54, s54, s55
    s_add_u32 s54, s54, 15104
    v_mov_b32 v44, s54
    s_mov_b32 s96, 0
L_mbw:
    ds_read_b32 v45, v44
    s_waitcnt lgkmcnt(0)
    v_readfirstlane_b32 s54, v45
    s_lshr_b32 s55, s54, 8
    s_cmp_eq_u32 s55, s59
    s_cbranch_scc1 L_mbok
    s_add_u32 s96, s96, 1
    s_cmp_lt_u32 s96, 0x8000
    s_cbranch_scc0 L_dyndone
    s_sleep 1
    s_branch L_mbw
L_mbok:
    s_and_b32 s54, s54, 0xff
    s_cmp_ge_u32 s54, 64
    s_cbranch_scc1 L_dyndone
    s_cmp_ge_u32 s54, 64
    s_cbranch_scc1 L_halfit
    s_lshl_b32 s54, s54, 13
    s_add_u32 s98, s100, s54
    s_add_u32 s99, s98, 4096
    s_branch L_gotoff
L_halfit:
    s_sub_u32 s54, s54, 64
    s_lshl_b32 s54, s54, 12
    s_add_u32 s54, s54, 524288
    s_add_u32 s98, s100, s54
    s_mov_b32 s99, 0x7f000000
    s_mov_b32 s13, 0xf149f2ca
    s_branch L_gotoff
L_dyndone:
    v_mov_b32 v44, 16
    s_mov_b32 s96, 0
Lw_5:
    ds_read_b32 v45, v44
    s_waitcnt lgkmcnt(0)
    v_readfirstlane_b32 s54, v45
    s_cmp_ge_u32 s54, 4
    s_cbranch_scc1 Lwd_6
    s_add_u32 s96, s96, 1
    s_cmp_ge_u32 s96, 0x8000
    s_cbranch_scc1 Lwd_6
    s_sleep 1
    s_branch Lw_5
Lwd_6:
    s_cmp_ge_u32 s3, 3
    s_cbranch_scc1 L_nowo
    v_lshlrev_b32 v44, 4, v1
    s_lshl_b32 s54, s3, 15
    s_add_u32 s54, s54, 61440
    v_add_u32 v44, s54, v44
    ds_read_b128 v[112:115], v44 offset:0
    ds_read_b128 v[116:119], v44 offset:1024
    ds_read_b128 v[120:123], v44 offset:2048
    ds_read_b128 v[124:127], v44 offset:3072
    ds_read_b128 v[128:131], v44 offset:4096
    ds_read_b128 v[132:135], v44 offset:5120
    ds_read_b128 v[136:139], v44 offset:6144
    ds_read_b128 v[140:143], v44 offset:7168
    ds_read_b128 v[144:147], v44 offset:8192
    ds_read_b128 v[148:151], v44 offset:9216
    ds_read_b128 v[152:155], v44 offset:10240
    ds_read_b128 v[156:159], v44 offset:11264
    ds_read_b128 v[160:163], v44 offset:12288
    ds_read_b128 v[164:167], v44 offset:13312
    ds_read_b128 v[168:171], v44 offset:14336
    ds_read_b128 v[172:175], v44 offset:15360
    ds_read_b128 v[176:179], v44 offset:16384
    ds_read_b128 v[180:183], v44 offset:17408
    ds_read_b128 v[184:187], v44 offset:18432
    ds_read_b128 v[188:191], v44 offset:19456
    ds_read_b128 v[192:195], v44 offset:20480
    ds_read_b128 v[196:199], v44 offset:21504
    ds_read_b128 v[200:203], v44 offset:22528
    ds_read_b128 v[204:207], v44 offset:23552
    ds_read_b128 v[208:211], v44 offset:24576
    ds_read_b128 v[212:215], v44 offset:25600
    ds_read_b128 v[216:219], v44 offset:26624
    ds_read_b128 v[220:223], v44 offset:27648
    ds_read_b128 v[224:227], v44 offset:28672
    ds_read_b128 v[228:231], v44 offset:29696
    ds_read_b128 v[232:235], v44 offset:30720
    ds_read_b128 v[236:239], v44 offset:31744
L_nowo:
    s_waitcnt vmcnt(15)
    v_dot2_f32_bf16 v20, v48, v4, 0
    v_dot2_f32_bf16 v20, v49, v5, v20
    v_dot2_f32_bf16 v20, v50, v6, v20
    v_dot2_f32_bf16 v20, v51, v7, v20
    s_waitcnt vmcnt(14)
    v_dot2_f32_bf16 v21, v52, v4, 0
    v_dot2_f32_bf16 v21, v53, v5, v21
    v_dot2_f32_bf16 v21, v54, v6, v21
    v_dot2_f32_bf16 v21, v55, v7, v21
    s_waitcnt vmcnt(13)
    v_dot2_f32_bf16 v22, v56, v4, 0
    v_dot2_f32_bf16 v22, v57, v5, v22
    v_dot2_f32_bf16 v22, v58, v6, v22
    v_dot2_f32_bf16 v22, v59, v7, v22
    s_waitcnt vmcnt(12)
    v_dot2_f32_bf16 v23, v60, v4, 0
    v_dot2_f32_bf16 v23, v61, v5, v23
    v_dot2_f32_bf16 v23, v62, v6, v23
    v_dot2_f32_bf16 v23, v63, v7, v23
    s_waitcnt vmcnt(11)
    v_dot2_f32_bf16 v24, v64, v4, 0
    v_dot2_f32_bf16 v24, v65, v5, v24
    v_dot2_f32_bf16 v24, v66, v6, v24
    v_dot2_f32_bf16 v24, v67, v7, v24
    s_waitcnt vmcnt(10)
    v_dot2_f32_bf16 v25, v68, v4, 0
    v_dot2_f32_bf16 v25, v69, v5, v25
    v_dot2_f32_bf16 v25, v70, v6, v25
    v_dot2_f32_bf16 v25, v71, v7, v25
    s_waitcnt vmcnt(9)
    v_dot2_f32_bf16 v26, v72, v4, 0
    v_dot2_f32_bf16 v26, v73, v5, v26
    v_dot2_f32_bf16 v26, v74, v6, v26
    v_dot2_f32_bf16 v26, v75, v7, v26
    s_waitcnt vmcnt(8)
    v_dot2_f32_bf16 v27, v76, v4, 0
    v_dot2_f32_bf16 v27, v77, v5, v27
    v_dot2_f32_bf16 v27, v78, v6, v27
    v_dot2_f32_bf16 v27, v79, v7, v27
    v_permlane16_swap_b32 v20, v21
    v_permlane16_swap_b32 v22, v23
    v_permlane16_swap_b32 v24, v25
    v_permlane16_swap_b32 v26, v27
    v_add_f32 v20, v20, v21
    v_add_f32 v22, v22, v23
    v_add_f32 v24, v24, v25
    v_add_f32 v26, v26, v27
    v_add_f32_dpp v20, v20, v20 row_ror:8 row_mask:0xf bank_mask:0xf
    v_add_f32_dpp v22, v22, v22 row_ror:8 row_mask:0xf bank_mask:0xf
    v_add_f32_dpp v24, v24, v24 row_ror:8 row_mask:0xf bank_mask:0xf
    v_add_f32_dpp v26, v26, v26 row_ror:8 row_mask:0xf bank_mask:0xf
    v_add_f32_dpp v20, v20, v20 row_ror:4 row_mask:0xf bank_mask:0xf
    v_add_f32_dpp v22, v22, v22 row_ror:4 row_mask:0xf bank_mask:0xf
    v_add_f32_dpp v24, v24, v24 row_ror:4 row_mask:0xf bank_mask:0xf
    v_add_f32_dpp v26, v26, v26 row_ror:4 row_mask:0xf bank_mask:0xf
    v_add_f32_dpp v20, v20, v20 row_ror:2 row_mask:0xf bank_mask:0xf
    v_add_f32_dpp v22, v22, v22 row_ror:2 row_mask:0xf bank_mask:0xf
    v_add_f32_dpp v24, v24, v24 row_ror:2 row_mask:0xf bank_mask:0xf
    v_add_f32_dpp v26, v26, v26 row_ror:2 row_mask:0xf bank_mask:0xf
    v_add_f32_dpp v20, v20, v20 row_ror:1 row_mask:0xf bank_mask:0xf
    v_add_f32_dpp v22, v22, v22 row_ror:1 row_mask:0xf bank_mask:0xf
    v_add_f32_dpp v24, v24, v24 row_ror:1 row_mask:0xf bank_mask:0xf
    v_add_f32_dpp v26, v26, v26 row_ror:1 row_mask:0xf bank_mask:0xf
    v_cvt_pk_bf16_f32 v44, v20, v22
    v_lshlrev_b32 v20, 16, v44
    v_and_b32 v22, 0xffff0000, v44
    v_cvt_pk_bf16_f32 v45, v24, v26
    v_lshlrev_b32 v24, 16, v45
    v_and_b32 v26, 0xffff0000, v45
    v_max3_f32 v19, v20, v22, v24
    v_max_f32 v19, v19, v26
    v_mov_b32 v44, v19
    s_nop 1
    v_permlane16_swap_b32 v19, v44
    v_max_f32 v19, v19, v44
    v_mov_b32 v44, v19
    s_nop 1
    v_permlane32_swap_b32 v19, v44
    v_max_f32 v19, v19, v44
    v_mul_f32 v19, s97, v19
    v_max_f32 v19, v19, v17
    v_sub_f32 v18, v17, v19
    v_mov_b32 v17, v19
    v_exp_f32 v18, v18
    v_fma_f32 v20, v20, s97, -v17
    v_fma_f32 v22, v22, s97, -v17
    v_fma_f32 v24, v24, s97, -v17
    v_fma_f32 v26, v26, s97, -v17
    v_exp_f32 v20, v20
    v_exp_f32 v22, v22
    v_exp_f32 v24, v24
    v_exp_f32 v26, v26
    v_add_f32 v44, v20, v22
    v_add_f32 v45, v24, v26
    v_add_f32 v44, v44, v45
    v_fma_f32 v16, v16, v18, v44
    v_mul_f32 v8, v8, v18
    v_mul_f32 v9, v9, v18
    v_mul_f32 v10, v10, v18
    v_mul_f32 v11, v11, v18
    v_mul_f32 v12, v12, v18
    v_mul_f32 v13, v13, v18
    v_mul_f32 v14, v14, v18
    v_mul_f32 v15, v15, v18
    v_cvt_pk_bf16_f32 v28, v20, 0
    v_cvt_pk_bf16_f32 v30, v22, 0
    v_cvt_pk_bf16_f32 v32, v24, 0
    v_cvt_pk_bf16_f32 v34, v26, 0
    v_mov_b32 v29, v28
    v_mov_b32 v31, v30
    v_mov_b32 v33, v32
    v_mov_b32 v35, v34
    v_permlane16_swap_b32 v28, v29
    v_permlane16_swap_b32 v30, v31
    v_permlane16_swap_b32 v32, v33
    v_permlane16_swap_b32 v34, v35
    v_lshlrev_b32 v36, 16, v28
    v_lshlrev_b32 v37, 16, v29
    v_lshlrev_b32 v38, 16, v30
    v_lshlrev_b32 v39, 16, v31
    v_lshlrev_b32 v40, 16, v32
    v_lshlrev_b32 v41, 16, v33
    v_lshlrev_b32 v42, 16, v34
    v_lshlrev_b32 v43, 16, v35
    s_waitcnt vmcnt(7)
    v_dot2c_f32_bf16 v8, v80, v28
    v_dot2c_f32_bf16 v9, v80, v36
    v_dot2c_f32_bf16 v10, v81, v28
    v_dot2c_f32_bf16 v11, v81, v36
    v_dot2c_f32_bf16 v12, v82, v28
    v_dot2c_f32_bf16 v13, v82, v36
    v_dot2c_f32_bf16 v14, v83, v28
    v_dot2c_f32_bf16 v15, v83, v36
    s_waitcnt vmcnt(6)
    v_dot2c_f32_bf16 v8, v84, v29
    v_dot2c_f32_bf16 v9, v84, v37
    v_dot2c_f32_bf16 v10, v85, v29
    v_dot2c_f32_bf16 v11, v85, v37
    v_dot2c_f32_bf16 v12, v86, v29
    v_dot2c_f32_bf16 v13, v86, v37
    v_dot2c_f32_bf16 v14, v87, v29
    v_dot2c_f32_bf16 v15, v87, v37
    s_waitcnt vmcnt(5)
    v_dot2c_f32_bf16 v8, v88, v30
    v_dot2c_f32_bf16 v9, v88, v38
    v_dot2c_f32_bf16 v10, v89, v30
    v_dot2c_f32_bf16 v11, v89, v38
    v_dot2c_f32_bf16 v12, v90, v30
    v_dot2c_f32_bf16 v13, v90, v38
    v_dot2c_f32_bf16 v14, v91, v30
    v_dot2c_f32_bf16 v15, v91, v38
    s_waitcnt vmcnt(4)
    v_dot2c_f32_bf16 v8, v92, v31
    v_dot2c_f32_bf16 v9, v92, v39
    v_dot2c_f32_bf16 v10, v93, v31
    v_dot2c_f32_bf16 v11, v93, v39
    v_dot2c_f32_bf16 v12, v94, v31
    v_dot2c_f32_bf16 v13, v94, v39
    v_dot2c_f32_bf16 v14, v95, v31
    v_dot2c_f32_bf16 v15, v95, v39
    s_waitcnt vmcnt(3)
    v_dot2c_f32_bf16 v8, v96, v32
    v_dot2c_f32_bf16 v9, v96, v40
    v_dot2c_f32_bf16 v10, v97, v32
    v_dot2c_f32_bf16 v11, v97, v40
    v_dot2c_f32_bf16 v12, v98, v32
    v_dot2c_f32_bf16 v13, v98, v40
    v_dot2c_f32_bf16 v14, v99, v32
    v_dot2c_f32_bf16 v15, v99, v40
    s_waitcnt vmcnt(2)
    v_dot2c_f32_bf16 v8, v100, v33
    v_dot2c_f32_bf16 v9, v100, v41
    v_dot2c_f32_bf16 v10, v101, v33
    v_dot2c_f32_bf16 v11, v101, v41
    v_dot2c_f32_bf16 v12, v102, v33
    v_dot2c_f32_bf16 v13, v102, v41
    v_dot2c_f32_bf16 v14, v103, v33
    v_dot2c_f32_bf16 v15, v103, v41
    s_waitcnt vmcnt(1)
    v_dot2c_f32_bf16 v8, v104, v34
    v_dot2c_f32_bf16 v9, v104, v42
    v_dot2c_f32_bf16 v10, v105, v34
    v_dot2c_f32_bf16 v11, v105, v42
    v_dot2c_f32_bf16 v12, v106, v34
    v_dot2c_f32_bf16 v13, v106, v42
    v_dot2c_f32_bf16 v14, v107, v34
    v_dot2c_f32_bf16 v15, v107, v42
    s_waitcnt vmcnt(0)
    v_dot2c_f32_bf16 v8, v108, v35
    v_dot2c_f32_bf16 v9, v108, v43
    v_dot2c_f32_bf16 v10, v109, v35
    v_dot2c_f32_bf16 v11, v109, v43
    v_dot2c_f32_bf16 v12, v110, v35
    v_dot2c_f32_bf16 v13, v110, v43
    v_dot2c_f32_bf16 v14, v111, v35
    v_dot2c_f32_bf16 v15, v111, v43
    v_cvt_pk_bf16_f32 v28, v8, v9
    v_cvt_pk_bf16_f32 v29, v10, v11
    v_cvt_pk_bf16_f32 v30, v12, v13
    v_cvt_pk_bf16_f32 v31, v14, v15
    v_lshrrev_b32 v44, 5, v1
    s_lshl_b32 s54, s3, 1
    v_add_u32 v44, s54, v44
    v_mul_u32_u24 v44, 544, v44
    v_and_b32 v45, 31, v1
    v_lshl_add_u32 v44, v45, 4, v44
    ds_write_b128 v44, v[28:31] offset:8960
    v_mov_b32 v45, v16
    s_nop 1
    v_permlane16_swap_b32 v16, v45
    v_add_f32 v16, v16, v45
    v_mov_b32 v45, v16
    s_nop 1
    v_permlane32_swap_b32 v16, v45
    v_add_f32 v33, v16, v45
    v_mov_b32 v32, v17
    s_lshl_b32 s54, s3, 3
    s_add_u32 s54, s54, 64
    v_mov_b32 v44, s54
    s_mov_b64 exec, 1
    ds_write_b64 v44, v[32:33]
    s_mov_b64 exec, -1
    s_waitcnt lgkmcnt(0)
    s_barrier
    s_cmp_eq_u32 s3, 3
    s_cbranch_scc1 L_s3
    s_add_u32 s56, s3, 4
    v_and_b32 v96, 7, v1
    v_mul_u32_u24 v96, 544, v96
    v_lshrrev_b32 v98, 4, v1
    v_lshl_add_u32 v96, v98, 4, v96
    v_mov_b32 v99, 64
    ds_read_b128 v[100:103], v99
    ds_read_b128 v[104:107], v99 offset:16
    ds_read_b128 v[48:51], v96 offset:8960
    ds_read_b128 v[52:55], v96 offset:9024
    ds_read_b128 v[56:59], v96 offset:9088
    ds_read_b128 v[60:63], v96 offset:9152
    ds_read_b128 v[64:67], v96 offset:9216
    ds_read_b128 v[68:71], v96 offset:9280
    ds_read_b128 v[72:75], v96 offset:9344
    ds_read_b128 v[76:79], v96 offset:9408
    v_bfe_u32 v96, v1, 2, 2
    v_lshlrev_b32 v96, 6, v96
    v_bfe_u32 v98, v1, 4, 1
    v_lshl_add_u32 v96, v98, 5, v96
    v_and_b32 v98, 3, v1
    v_lshl_add_u32 v96, v98, 3, v96
    s_mul_i32 s54, s14, 1792
    s_lshl_b32 s55, s56, 8
    s_add_u32 s54, s54, s55
    s_add_u32 s54, s54, 0x30000
    s_waitcnt lgkmcnt(7)
    v_mfma_f32_16x16x32_bf16 v[80:83], v[48:51], v[112:115], 0
    v_mfma_f32_16x16x32_bf16 v[84:87], v[48:51], v[116:119], 0
    v_mfma_f32_16x16x32_bf16 v[88:91], v[48:51], v[120:123], 0
    v_mfma_f32_16x16x32_bf16 v[92:95], v[48:51], v[124:127], 0
    v_max3_f32 v108, v100, v102, v104
    v_max_f32 v108, v108, v106
    v_sub_f32 v100, v100, v108
    v_sub_f32 v102, v102, v108
    v_sub_f32 v104, v104, v108
    v_sub_f32 v106, v106, v108
    v_exp_f32 v100, v100
    v_exp_f32 v102, v102
    v_exp_f32 v104, v104
    v_exp_f32 v106, v106
    v_cndmask_b32 v109, v100, v104, s[52:53]
    v_cndmask_b32 v110, v102, v106, s[52:53]
    v_mov_b32 v99, s32
    s_waitcnt lgkmcnt(6)
    v_mfma_f32_16x16x32_bf16 v[80:83], v[52:55], v[128:131], v[80:83]
    v_mfma_f32_16x16x32_bf16 v[84:87], v[52:55], v[132:135], v[84:87]
    v_mfma_f32_16x16x32_bf16 v[88:91], v[52:55], v[136:139], v[88:91]
    v_mfma_f32_16x16x32_bf16 v[92:95], v[52:55], v[140:143], v[92:95]
    s_waitcnt lgkmcnt(5)
    v_mfma_f32_16x16x32_bf16 v[80:83], v[56:59], v[144:147], v[80:83]
    v_mfma_f32_16x16x32_bf16 v[84:87], v[56:59], v[148:151], v[84:87]
    v_mfma_f32_16x16x32_bf16 v[88:91], v[56:59], v[152:155], v[88:91]
    v_mfma_f32_16x16x32_bf16 v[92:95], v[56:59], v[156:159], v[92:95]
    s_waitcnt lgkmcnt(4)
    v_mfma_f32_16x16x32_bf16 v[80:83], v[60:63], v[160:163], v[80:83]
    v_mfma_f32_16x16x32_bf16 v[84:87], v[60:63], v[164:167], v[84:87]
    v_mfma_f32_16x16x32_bf16 v[88:91], v[60:63], v[168:171], v[88:91]
    v_mfma_f32_16x16x32_bf16 v[92:95], v[60:63], v[172:175], v[92:95]
    s_waitcnt lgkmcnt(3)
    v_mfma_f32_16x16x32_bf16 v[80:83], v[64:67], v[176:179], v[80:83]
    v_mfma_f32_16x16x32_bf16 v[84:87], v[64:67], v[180:183], v[84:87]
    v_mfma_f32_16x16x32_bf16 v[88:91], v[64:67], v[184:187], v[88:91]
    v_mfma_f32_16x16x32_bf16 v[92:95], v[64:67], v[188:191], v[92:95]
    s_waitcnt lgkmcnt(2)
    v_mfma_f32_16x16x32_bf16 v[80:83], v[68:71], v[192:195], v[80:83]
    v_mfma_f32_16x16x32_bf16 v[84:87], v[68:71], v[196:199], v[84:87]
    v_mfma_f32_16x16x32_bf16 v[88:91], v[68:71], v[200:203], v[88:91]
    v_mfma_f32_16x16x32_bf16 v[92:95], v[68:71], v[204:207], v[92:95]
    s_waitcnt lgkmcnt(1)
    v_mfma_f32_16x16x32_bf16 v[80:83], v[72:75], v[208:211], v[80:83]
    v_mfma_f32_16x16x32_bf16 v[84:87], v[72:75], v[212:215], v[84:87]
    v_mfma_f32_16x16x32_bf16 v[88:91], v[72:75], v[216:219], v[88:91]
    v_mfma_f32_16x16x32_bf16 v[92:95], v[72:75], v[220:223], v[92:95]
    s_waitcnt lgkmcnt(0)
    v_mfma_f32_16x16x32_bf16 v[80:83], v[76:79], v[224:227], v[80:83]
    v_mfma_f32_16x16x32_bf16 v[84:87], v[76:79], v[228:231], v[84:87]
    v_mfma_f32_16x16x32_bf16 v[88:91], v[76:79], v[232:235], v[88:91]
    v_mfma_f32_16x16x32_bf16 v[92:95], v[76:79], v[236:239], v[92:95]
    s_nop 4
    v_add_f32 v80, v80, v81
    v_add_f32 v82, v82, v83
    v_add_f32 v84, v84, v85
    v_add_f32 v86, v86, v87
    v_add_f32 v88, v88, v89
    v_add_f32 v90, v90, v91
    v_add_f32 v92, v92, v93
    v_add_f32 v94, v94, v95
    v_mul_f32 v80, v80, v109
    v_fmac_f32 v80, v82, v110
    v_mul_f32 v84, v84, v109
    v_fmac_f32 v84, v86, v110
    v_mul_f32 v88, v88, v109
    v_fmac_f32 v88, v90, v110
    v_mul_f32 v92, v92, v109
    v_fmac_f32 v92, v94, v110
    v_permlane16_swap_b32 v80, v84
    s_nop 0
    v_permlane16_swap_b32 v88, v92
    v_add_f32 v80, v80, v84
    v_add_f32 v88, v88, v92
    v_cvt_pk_bf16_f32 v98, v80, v88
    s_mov_b32 exec_hi, 0
    buffer_store_dwordx2 v[98:99], v96, s[36:39], s54 offen sc1
    s_mov_b64 exec, -1
    s_and_b32 s54, s2, 63
    s_cmp_ge_u32 s54, 56
    s_cbranch_scc1 L_fin
    s_cmp_ge_u32 s3, 2
    s_cbranch_scc1 L_s_b2
    s_lshr_b32 s55, s2, 6
    s_lshl_b32 s55, s55, 1
    s_add_u32 s55, s55, s3
    s_mul_i32 s55, s55, 1792
    s_add_u32 s55, s55, 0x112000
    v_lshlrev_b32 v44, 4, v1
    v_add_u32 v47, 1024, v44
    v_cmp_gt_u32 vcc, 48, v1
    s_mov_b64 s[60:61], vcc
    v_cndmask_b32 v47, v44, v47, s[60:61]
    s_mul_i32 s56, s3, 1792
    v_add_u32 v46, s56, v44
    ds_read_b128 v[64:67], v46 offset:1792
    ds_read_b128 v[68:71], v46 offset:2816
    ds_read_b128 v[72:75], v46 offset:5376
    ds_read_b128 v[76:79], v46 offset:6400
    v_mov_b32 v84, 40
    s_mov_b32 s96, 0
Lw_7:
    ds_read_b32 v85, v84
    s_waitcnt lgkmcnt(0)
    v_readfirstlane_b32 s54, v85
    s_cmp_ge_u32 s54, 1
    s_cbranch_scc1 Lwd_8
    s_add_u32 s96, s96, 1
    s_cmp_ge_u32 s96, 0x8000
    s_cbranch_scc1 Lwd_8
    s_sleep 1
    s_branch Lw_7
Lwd_8:
    s_mov_b32 s96, 0
Lr_9:
    buffer_load_dwordx4 v[48:51], v44, s[36:39], s55 offen sc1
    buffer_load_dwordx4 v[52:55], v47, s[36:39], s55 offen sc1
    s_waitcnt vmcnt(0)
    v_xor_b32 v49, s32, v49
    v_xor_b32 v51, s32, v51
    v_or_b32 v49, v49, v51
    v_xor_b32 v53, s32, v53
    v_or_b32 v49, v49, v53
    v_xor_b32 v55, s32, v55
    v_or_b32 v49, v49, v55
    v_cmp_ne_u32 vcc, 0, v49
    s_cmp_eq_u64 vcc, 0
    s_cbranch_scc1 Lrd_10
    s_add_u32 s96, s96, 1
    s_cmp_ge_u32 s96, 0x8000
    s_cbranch_scc1 Lrd_10
    s_sleep 2
    s_branch Lr_9
Lrd_10:
    v_lshlrev_b32 v56, 16, v48
    v_and_b32 v57, 0xffff0000, v48
    v_lshlrev_b32 v58, 16, v50
    v_and_b32 v59, 0xffff0000, v50
    v_lshlrev_b32 v60, 16, v52
    v_and_b32 v61, 0xffff0000, v52
    v_lshlrev_b32 v62, 16, v54
    v_and_b32 v63, 0xffff0000, v54
    v_cndmask_b32 v60, 0, v60, s[60:61]
    v_cndmask_b32 v61, 0, v61, s[60:61]
    v_cndmask_b32 v62, 0, v62, s[60:61]
    v_cndmask_b32 v63, 0, v63, s[60:61]
    v_add_f32 v20, v56, v57
    v_mul_f32 v22, v56, v56
    v_fmac_f32 v22, v57, v57
    v_add_f32 v20, v20, v58
    v_fmac_f32 v22, v58, v58
    v_add_f32 v20, v20, v59
    v_fmac_f32 v22, v59, v59
    v_add_f32 v20, v20, v60
    v_fmac_f32 v22, v60, v60
    v_add_f32 v20, v20, v61
    v_fmac_f32 v22, v61, v61
    v_add_f32 v20, v20, v62
    v_fmac_f32 v22, v62, v62
    v_add_f32 v20, v20, v63
    v_fmac_f32 v22, v63, v63
    s_nop 0
    v_add_f32_dpp v20, v20, v20 row_ror:8 row_mask:0xf bank_mask:0xf
    v_add_f32_dpp v22, v22, v22 row_ror:8 row_mask:0xf bank_mask:0xf
    s_nop 0
    v_add_f32_dpp v20, v20, v20 row_ror:4 row_mask:0xf bank_mask:0xf
    v_add_f32_dpp v22, v22, v22 row_ror:4 row_mask:0xf bank_mask:0xf
    s_nop 0
    v_add_f32_dpp v20, v20, v20 row_ror:2 row_mask:0xf bank_mask:0xf
    v_add_f32_dpp v22, v22, v22 row_ror:2 row_mask:0xf bank_mask:0xf
    s_nop 0
    v_add_f32_dpp v20, v20, v20 row_ror:1 row_mask:0xf bank_mask:0xf
    v_add_f32_dpp v22, v22, v22 row_ror:1 row_mask:0xf bank_mask:0xf
    v_mov_b32 v21, v20
    v_mov_b32 v23, v22
    s_nop 0
    v_permlane16_swap_b32 v20, v21
    v_permlane16_swap_b32 v22, v23
    v_add_f32 v20, v20, v21
    v_add_f32 v22, v22, v23
    v_mov_b32 v21, v20
    v_mov_b32 v23, v22
    s_nop 0
    v_permlane32_swap_b32 v20, v21
    v_permlane32_swap_b32 v22, v23
    v_add_f32 v20, v20, v21
    v_add_f32 v22, v22, v23
    v_mul_f32 v20, 0x3b124925, v20
    v_mul_f32 v22, 0x3b124925, v22
    v_fma_f32 v22, -v20, v20, v22
    v_max_f32 v22, 0, v22
    v_add_f32 v22, 0x3727c5ac, v22
    v_rsq_f32 v22, v22
    s_waitcnt lgkmcnt(0)
    v_sub_f32 v56, v56, v20
    v_mul_f32 v64, v64, v22
    v_sub_f32 v57, v57, v20
    v_mul_f32 v65, v65, v22
    v_sub_f32 v58, v58, v20
    v_mul_f32 v66, v66, v22
    v_sub_f32 v59, v59, v20
    v_mul_f32 v67, v67, v22
    v_sub_f32 v60, v60, v20
    v_mul_f32 v68, v68, v22
    v_sub_f32 v61, v61, v20
    v_mul_f32 v69, v69, v22
    v_sub_f32 v62, v62, v20
    v_mul_f32 v70, v70, v22
    v_sub_f32 v63, v63, v20
    v_mul_f32 v71, v71, v22
    v_fma_f32 v56, v56, v64, v72
    v_fma_f32 v57, v57, v65, v73
    v_fma_f32 v58, v58, v66, v74
    v_fma_f32 v59, v59, v67, v75
    v_fma_f32 v60, v60, v68, v76
    v_fma_f32 v61, v61, v69, v77
    v_fma_f32 v62, v62, v70, v78
    v_fma_f32 v63, v63, v71, v79
    v_cvt_pk_bf16_f32 v28, v56, v57
    v_cvt_pk_bf16_f32 v29, v58, v59
    v_cvt_pk_bf16_f32 v30, v60, v61
    v_cvt_pk_bf16_f32 v31, v62, v63
    s_mul_i32 s56, s3, 896
    v_lshlrev_b32 v46, 3, v1
    v_add_u32 v46, s56, v46
    ds_write_b64 v46, v[28:29] offset:13312
    s_mov_b64 exec, s[60:61]
    ds_write_b64 v46, v[30:31] offset:13824
    s_mov_b64 exec, -1
    s_waitcnt lgkmcnt(0)
L_s_b2:
    s_barrier
    s_barrier
    s_branch L_fin
L_s3:
    v_mov_b32 v44, 64
    ds_read_b128 v[48:51], v44
    ds_read_b128 v[52:55], v44 offset:16
    v_and_b32 v45, 1, v1
    v_lshlrev_b32 v45, 3, v45
    v_bfe_u32 v46, v1, 4, 1
    v_lshl_add_u32 v45, v46, 2, v45
    v_lshrrev_b32 v46, 5, v1
    v_lshl_add_u32 v45, v46, 1, v45
    v_bfe_u32 v46, v1, 1, 1
    v_add_u32 v45, v45, v46
    v_lshlrev_b32 v46, 2, v45
    ds_read_b32 v40, v46 offset:1536
    ds_read_b32 v41, v46 offset:1600
    ds_read_b32 v42, v46 offset:1664
    s_waitcnt lgkmcnt(0)
    v_max3_f32 v56, v48, v50, v52
    v_max_f32 v56, v56, v54
    v_sub_f32 v48, v48, v56
    v_sub_f32 v50, v50, v56
    v_sub_f32 v52, v52, v56
    v_sub_f32 v54, v54, v56
    v_exp_f32 v48, v48
    v_exp_f32 v50, v50
    v_exp_f32 v52, v52
    v_exp_f32 v54, v54
    v_mul_f32 v58, v48, v49
    v_fmac_f32 v58, v50, v51
    v_fmac_f32 v58, v52, v53
    v_fmac_f32 v58, v54, v55
    v_mov_b32 v57, s32
    v_mov_b32 v59, s32
    s_lshl_b32 s54, s14, 4
    s_add_u32 s54, s54, 0x110000
    v_mov_b32 v44, 0
    s_mov_b64 exec, 1
    buffer_store_dwordx4 v[56:59], v44, s[36:39], s54 offen sc1
    s_mov_b64 exec, -1
    s_and_b32 s58, s2, 31
    v_lshrrev_b32 v43, 2, v1
    v_mul_u32_u24 v44, 1792, v43
    v_and_b32 v47, 3, v1
    v_lshl_add_u32 v44, v47, 4, v44
    v_and_b32 v46, 31, v1
    v_lshlrev_b32 v46, 4, v46
    s_mul_i32 s55, s33, 57344
    s_lshl_b32 s56, s58, 6
    s_add_u32 s55, s55, s56
    s_add_u32 s55, s55, 0x30000
    s_add_u32 s57, s55, 28672
    s_lshl_b32 s56, s33, 9
    s_add_u32 s56, s56, 0x110000
    s_mov_b32 s96, 0
    s_mov_b32 s59, 0
L_mlp:
    buffer_load_dwordx4 v[80:83], v46, s[36:39], s56 offen sc1
    s_cmp_eq_u32 s59, 0
    s_cbranch_scc1 L_mlp1
    buffer_load_dwordx4 v[64:67], v44, s[36:39], s55 offen sc1
    buffer_load_dwordx4 v[68:71], v44, s[36:39], s57 offen sc1
L_mlp1:
    s_waitcnt vmcnt(0)
    v_xor_b32 v81, s32, v81
    v_xor_b32 v83, s32, v83
    v_or_b32 v81, v81, v83
    v_cmp_ne_u32 vcc, 0, v81
    s_bcnt1_i32_b64 s54, vcc
    s_cmp_eq_u32 s54, 0
    s_cbranch_scc1 L_mlok
    s_add_u32 s96, s96, 1
    s_cmp_ge_u32 s96, 0x8000
    s_cbranch_scc1 L_mlok
    s_cmp_le_u32 s54, 0
    s_cselect_b32 s59, 1, 0
    s_cmp_ge_u32 s58, 28
    s_cselect_b32 s59, 0, s59
    s_sleep 4
    s_branch L_mlp
L_mlok:
    s_cmp_ge_u32 s58, 28
    s_cbranch_scc1 L_s3_nor1
    s_cmp_lg_u32 s59, 0
    s_cbranch_scc1 L_mlok1
    buffer_load_dwordx4 v[64:67], v44, s[36:39], s55 offen sc1
    buffer_load_dwordx4 v[68:71], v44, s[36:39], s57 offen sc1
L_mlok1:
    v_mov_b32_dpp v84, v80 quad_perm:[1,0,3,2] row_mask:0xf bank_mask:0xf
    v_mov_b32_dpp v85, v82 quad_perm:[1,0,3,2] row_mask:0xf bank_mask:0xf
    v_max_f32 v86, v80, v84
    v_sub_f32 v80, v80, v86
    v_sub_f32 v84, v84, v86
    v_exp_f32 v80, v80
    v_exp_f32 v84, v84
    v_mul_f32 v82, v82, v80
    v_fmac_f32 v82, v85, v84
    v_rcp_f32 v82, v82
    s_nop 0
    v_mul_f32 v80, v80, v82
    v_lshlrev_b32 v86, 2, v43
    ds_bpermute_b32 v81, v86, v80
    v_add_u32 v86, 64, v86
    ds_bpermute_b32 v83, v86, v80
    s_mov_b32 s96, 0
    s_branch Lp2_13
Lp_11:
    buffer_load_dwordx4 v[64:67], v44, s[36:39], s55 offen sc1
    buffer_load_dwordx4 v[68:71], v44, s[36:39], s57 offen sc1
Lp2_13:
    s_waitcnt vmcnt(0)
    v_xor_b32 v65, s32, v65
    v_xor_b32 v67, s32, v67
    v_or_b32 v65, v65, v67
    v_xor_b32 v69, s32, v69
    v_or_b32 v65, v65, v69
    v_xor_b32 v71, s32, v71
    v_or_b32 v65, v65, v71
    v_cmp_ne_u32 vcc, 0, v65
    s_cmp_eq_u64 vcc, 0
    s_cbranch_scc1 Lpd_12
    s_add_u32 s96, s96, 1
    s_cmp_ge_u32 s96, 0x8000
    s_cbranch_scc1 Lpd_12
    s_sleep 2
    s_branch Lp_11
Lpd_12:
    v_lshlrev_b32 v88, 16, v64
    v_and_b32 v89, 0xffff0000, v64
    v_lshlrev_b32 v90, 16, v66
    v_and_b32 v91, 0xffff0000, v66
    v_lshlrev_b32 v92, 16, v68
    v_and_b32 v93, 0xffff0000, v68
    v_lshlrev_b32 v94, 16, v70
    v_and_b32 v95, 0xffff0000, v70
    s_waitcnt lgkmcnt(0)
    v_mul_f32 v88, v88, v81
    v_mul_f32 v89, v89, v81
    v_mul_f32 v90, v90, v81
    v_mul_f32 v91, v91, v81
    v_fmac_f32 v88, v92, v83
    v_fmac_f32 v89, v93, v83
    v_fmac_f32 v90, v94, v83
    v_fmac_f32 v91, v95, v83
    v_add_f32_dpp v88, v88, v88 row_ror:8 row_mask:0xf bank_mask:0xf
    v_add_f32_dpp v89, v89, v89 row_ror:8 row_mask:0xf bank_mask:0xf
    v_add_f32_dpp v90, v90, v90 row_ror:8 row_mask:0xf bank_mask:0xf
    v_add_f32_dpp v91, v91, v91 row_ror:8 row_mask:0xf bank_mask:0xf
    v_add_f32_dpp v88, v88, v88 row_ror:4 row_mask:0xf bank_mask:0xf
    v_add_f32_dpp v89, v89, v89 row_ror:4 row_mask:0xf bank_mask:0xf
    v_add_f32_dpp v90, v90, v90 row_ror:4 row_mask:0xf bank_mask:0xf
    v_add_f32_dpp v91, v91, v91 row_ror:4 row_mask:0xf bank_mask:0xf
    v_permlane32_swap_b32 v88, v89
    s_nop 0
    v_permlane32_swap_b32 v90, v91
    v_add_f32 v88, v88, v89
    v_add_f32 v90, v90, v91
    s_nop 1
    v_permlane16_swap_b32 v88, v90
    v_add_f32 v88, v88, v90
    v_cvt_pk_bf16_f32 v86, v88, v88
    v_lshlrev_b32 v88, 16, v86
    v_mul_f32 v88, v88, v41
    v_cvt_pk_bf16_f32 v86, v88, v88
    v_lshlrev_b32 v88, 16, v86
    v_add_f32 v88, v88, v40
    v_cvt_pk_bf16_f32 v86, v88, v88
    v_lshlrev_b32 v88, 16, v86
    v_mov_b32 v60, v88
    s_nop 0
    v_mov_b32_dpp v62, v88 quad_perm:[2,3,0,1] row_mask:0xf bank_mask:0xf
    v_cvt_pk_bf16_f32 v62, v88, v62
    v_mov_b32 v63, s32
    v_lshlrev_b32 v46, 2, v45
    s_mul_i32 s55, s33, 1792
    s_lshl_b32 s56, s58, 6
    s_add_u32 s55, s55, s56
    s_add_u32 s55, s55, 0x112000
    s_mov_b32 exec_lo, 0x00030003
    s_mov_b32 exec_hi, 0x00030003
    buffer_store_dwordx2 v[62:63], v46, s[36:39], s55 offen sc1
    s_mov_b64 exec, -1
    s_waitcnt vmcnt(0)
    v_mov_b32 v84, 40
    v_mov_b32 v85, 1
    s_mov_b64 exec, 1
    ds_write_b32 v84, v85
    s_mov_b64 exec, -1
    s_branch L_s3_b2
L_s3_nor1:
    s_mul_i32 s55, s33, 1792
    s_add_u32 s55, s55, 0x112000
    v_mov_b32 v46, 0
    s_mov_b64 exec, 1
    s_mov_b32 s96, 0
Lp_14:
    buffer_load_dwordx2 v[64:65], v46, s[36:39], s55 offen sc1
    s_waitcnt vmcnt(0)
    v_xor_b32 v65, s32, v65
    v_cmp_ne_u32 vcc, 0, v65
    s_cmp_eq_u64 vcc, 0
    s_cbranch_scc1 Lpd_15
    s_add_u32 s96, s96, 1
    s_cmp_ge_u32 s96, 0x8000
    s_cbranch_scc1 Lpd_15
    s_sleep 4
    s_branch Lp_14
Lpd_15:
    s_mov_b64 exec, -1
    v_mov_b32 v84, 40
    v_mov_b32 v85, 1
    s_mov_b64 exec, 1
    ds_write_b32 v84, v85
    s_mov_b64 exec, -1
L_s3_b2:
    v_mul_u32_u24 v44, 3584, v43
    v_and_b32 v47, 3, v1
    v_lshl_add_u32 v44, v47, 4, v44
    s_lshr_b32 s55, s2, 6
    s_mul_i32 s55, s55, 200704
    s_and_b32 s56, s33, 1
    s_mul_i32 s56, s56, 1792
    s_add_u32 s55, s55, s56
    s_lshl_b32 s56, s58, 6
    s_add_u32 s55, s55, s56
    s_add_u32 s55, s55, 0x120000
    s_add_u32 s56, s55, 57344
    s_add_u32 s57, s55, 114688
    v_add_u32 v47, 57344, v44
    s_mov_b32 s60, -1
    s_mov_b32 s61, 0
    v_cndmask_b32 v47, v44, v47, s[60:61]
    s_and_b32 s54, s2, 63
    s_cmp_ge_u32 s54, 56
    s_cbranch_scc1 L_s3_nob
    s_barrier
    s_barrier
    s_cmp_ge_u32 s58, 28
    s_cbranch_scc1 L_fin
    v_mov_b32 v84, 44
    s_mov_b32 s96, 0
Lw_16:
    ds_read_b32 v85, v84
    s_waitcnt lgkmcnt(0)
    v_readfirstlane_b32 s54, v85
    s_cmp_ge_u32 s54, 4
    s_cbranch_scc1 Lwd_17
    s_add_u32 s96, s96, 1
    s_cmp_ge_u32 s96, 0x8000
    s_cbranch_scc1 Lwd_17
    s_sleep 1
    s_branch Lw_16
Lwd_17:
    s_branch L_s3_go
L_s3_nob:
    s_cmp_ge_u32 s58, 28
    s_cbranch_scc1 L_fin
    s_mov_b64 exec, 1
    s_mov_b32 s96, 0
Lp_18:
    buffer_load_dwordx4 v[64:67], v44, s[36:39], s55 offen sc1
    s_waitcnt vmcnt(0)
    v_xor_b32 v65, s32, v65
    v_xor_b32 v67, s32, v67
    v_or_b32 v65, v65, v67
    v_cmp_ne_u32 vcc, 0, v65
    s_cmp_eq_u64 vcc, 0
    s_cbranch_scc1 Lpd_19
    s_add_u32 s96, s96, 1
    s_cmp_ge_u32 s96, 0x8000
    s_cbranch_scc1 Lpd_19
    s_sleep 6
    s_branch Lp_18
Lpd_19:
    s_mov_b64 exec, -1
L_s3_go:
    s_mov_b32 s96, 0
Lp_20:
    buffer_load_dwordx4 v[64:67], v44, s[36:39], s55 offen sc1
    buffer_load_dwordx4 v[68:71], v44, s[36:39], s56 offen sc1
    buffer_load_dwordx4 v[72:75], v44, s[36:39], s57 offen sc1
    buffer_load_dwordx4 v[76:79], v47, s[36:39], s57 offen sc1
    s_waitcnt vmcnt(0)
    v_xor_b32 v65, s32, v65
    v_xor_b32 v67, s32, v67
    v_or_b32 v65, v65, v67
    v_xor_b32 v69, s32, v69
    v_or_b32 v65, v65, v69
    v_xor_b32 v71, s32, v71
    v_or_b32 v65, v65, v71
    v_xor_b32 v73, s32, v73
    v_or_b32 v65, v65, v73
    v_xor_b32 v75, s32, v75
    v_or_b32 v65, v65, v75
    v_xor_b32 v77, s32, v77
    v_or_b32 v65, v65, v77
    v_xor_b32 v79, s32, v79
    v_or_b32 v65, v65, v79
    v_cmp_ne_u32 vcc, 0, v65
    s_cmp_eq_u64 vcc, 0
    s_cbranch_scc1 Lpd_21
    s_add_u32 s96, s96, 1
    s_cmp_ge_u32 s96, 0x8000
    s_cbranch_scc1 Lpd_21
    s_sleep 2
    s_branch Lp_20
Lpd_21:
    v_lshlrev_b32 v88, 16, v64
    v_and_b32 v89, 0xffff0000, v64
    v_lshlrev_b32 v90, 16, v66
    v_and_b32 v91, 0xffff0000, v66
    v_lshlrev_b32 v92, 16, v68
    v_and_b32 v93, 0xffff0000, v68
    v_lshlrev_b32 v94, 16, v70
    v_and_b32 v95, 0xffff0000, v70
    v_lshlrev_b32 v80, 16, v72
    v_and_b32 v81, 0xffff0000, v72
    v_lshlrev_b32 v82, 16, v74
    v_and_b32 v83, 0xffff0000, v74
    v_lshlrev_b32 v84, 16, v76
    v_and_b32 v85, 0xffff0000, v76
    v_lshlrev_b32 v86, 16, v78
    v_and_b32 v87, 0xffff0000, v78
    v_cndmask_b32 v84, 0, v84, s[60:61]
    v_cndmask_b32 v85, 0, v85, s[60:61]
    v_cndmask_b32 v86, 0, v86, s[60:61]
    v_cndmask_b32 v87, 0, v87, s[60:61]
    v_add_f32 v88, v88, v92
    v_add_f32 v89, v89, v93
    v_add_f32 v90, v90, v94
    v_add_f32 v91, v91, v95
    v_add_f32 v80, v80, v84
    v_add_f32 v81, v81, v85
    v_add_f32 v82, v82, v86
    v_add_f32 v83, v83, v87
    v_add_f32 v88, v88, v80
    v_add_f32 v89, v89, v81
    v_add_f32 v90, v90, v82
    v_add_f32 v91, v91, v83
    v_add_f32_dpp v88, v88, v88 row_ror:8 row_mask:0xf bank_mask:0xf
    v_add_f32_dpp v89, v89, v89 row_ror:8 row_mask:0xf bank_mask:0xf
    v_add_f32_dpp v90, v90, v90 row_ror:8 row_mask:0xf bank_mask:0xf
    v_add_f32_dpp v91, v91, v91 row_ror:8 row_mask:0xf bank_mask:0xf
    v_add_f32_dpp v88, v88, v88 row_ror:4 row_mask:0xf bank_mask:0xf
    v_add_f32_dpp v89, v89, v89 row_ror:4 row_mask:0xf bank_mask:0xf
    v_add_f32_dpp v90, v90, v90 row_ror:4 row_mask:0xf bank_mask:0xf
    v_add_f32_dpp v91, v91, v91 row_ror:4 row_mask:0xf bank_mask:0xf
    v_permlane32_swap_b32 v88, v89
    s_nop 0
    v_permlane32_swap_b32 v90, v91
    v_add_f32 v88, v88, v89
    v_add_f32 v90, v90, v91
    s_nop 1
    v_permlane16_swap_b32 v88, v90
    v_add_f32 v88, v88, v90
    v_cvt_pk_bf16_f32 v96, v88, v88
    v_lshlrev_b32 v88, 16, v96
    v_mul_f32 v88, v88, v42
    v_cvt_pk_bf16_f32 v96, v88, v88
    v_lshlrev_b32 v88, 16, v96
    v_add_f32 v88, v88, v60
    v_cvt_pk_bf16_f32 v88, v88, v88
    s_lshl_b32 s55, s58, 4
    s_mul_i32 s56, s33, 448
    s_add_u32 s55, s55, s56
    s_lshl_b32 s55, s55, 1
    v_lshlrev_b32 v46, 1, v45
    s_mov_b32 s40, s26
    s_mov_b32 s41, s27
    s_mov_b32 s42, 0x1c00
    s_mov_b32 s43, 0x00020000
    s_mov_b32 exec_lo, 0x000f000f
    s_mov_b32 exec_hi, 0x000f000f
    buffer_store_short v88, v46, s[40:43], s55 offen
    s_mov_b64 exec, -1
    s_branch L_fin
L_pcons:
    s_lshl_b32 s55, s3, 15
    s_add_u32 s55, s55, 32768
    v_lshlrev_b32 v46, 4, v1
    v_add_u32 v46, s55, v46
    s_waitcnt lgkmcnt(0)
    s_bitcmp1_b32 s101, 0
    s_cbranch_scc1 L_pc_odd
    v_dot2_f32_bf16 v20, v112, v4, 0
    v_dot2_f32_bf16 v20, v113, v5, v20
    v_dot2_f32_bf16 v20, v114, v6, v20
    v_dot2_f32_bf16 v20, v115, v7, v20
    v_dot2_f32_bf16 v21, v116, v4, 0
    v_dot2_f32_bf16 v21, v117, v5, v21
    v_dot2_f32_bf16 v21, v118, v6, v21
    v_dot2_f32_bf16 v21, v119, v7, v21
    v_dot2_f32_bf16 v22, v120, v4, 0
    v_dot2_f32_bf16 v22, v121, v5, v22
    v_dot2_f32_bf16 v22, v122, v6, v22
    v_dot2_f32_bf16 v22, v123, v7, v22
    v_dot2_f32_bf16 v23, v124, v4, 0
    v_dot2_f32_bf16 v23, v125, v5, v23
    v_dot2_f32_bf16 v23, v126, v6, v23
    v_dot2_f32_bf16 v23, v127, v7, v23
    v_dot2_f32_bf16 v24, v128, v4, 0
    v_dot2_f32_bf16 v24, v129, v5, v24
    v_dot2_f32_bf16 v24, v130, v6, v24
    v_dot2_f32_bf16 v24, v131, v7, v24
    v_dot2_f32_bf16 v25, v132, v4, 0
    v_dot2_f32_bf16 v25, v133, v5, v25
    v_dot2_f32_bf16 v25, v134, v6, v25
    v_dot2_f32_bf16 v25, v135, v7, v25
    v_dot2_f32_bf16 v26, v136, v4, 0
    v_dot2_f32_bf16 v26, v137, v5, v26
    v_dot2_f32_bf16 v26, v138, v6, v26
    v_dot2_f32_bf16 v26, v139, v7, v26
    v_dot2_f32_bf16 v27, v140, v4, 0
    v_dot2_f32_bf16 v27, v141, v5, v27
    v_dot2_f32_bf16 v27, v142, v6, v27
    v_dot2_f32_bf16 v27, v143, v7, v27
    v_permlane16_swap_b32 v20, v21
    v_permlane16_swap_b32 v22, v23
    v_permlane16_swap_b32 v24, v25
    v_permlane16_swap_b32 v26, v27
    v_add_f32 v20, v20, v21
    v_add_f32 v22, v22, v23
    v_add_f32 v24, v24, v25
    v_add_f32 v26, v26, v27
    v_add_f32_dpp v20, v20, v20 row_ror:8 row_mask:0xf bank_mask:0xf
    v_add_f32_dpp v22, v22, v22 row_ror:8 row_mask:0xf bank_mask:0xf
    v_add_f32_dpp v24, v24, v24 row_ror:8 row_mask:0xf bank_mask:0xf
    v_add_f32_dpp v26, v26, v26 row_ror:8 row_mask:0xf bank_mask:0xf
    v_add_f32_dpp v20, v20, v20 row_ror:4 row_mask:0xf bank_mask:0xf
    v_add_f32_dpp v22, v22, v22 row_ror:4 row_mask:0xf bank_mask:0xf
    v_add_f32_dpp v24, v24, v24 row_ror:4 row_mask:0xf bank_mask:0xf
    v_add_f32_dpp v26, v26, v26 row_ror:4 row_mask:0xf bank_mask:0xf
    v_add_f32_dpp v20, v20, v20 row_ror:2 row_mask:0xf bank_mask:0xf
    v_add_f32_dpp v22, v22, v22 row_ror:2 row_mask:0xf bank_mask:0xf
    v_add_f32_dpp v24, v24, v24 row_ror:2 row_mask:0xf bank_mask:0xf
    v_add_f32_dpp v26, v26, v26 row_ror:2 row_mask:0xf bank_mask:0xf
    v_add_f32_dpp v20, v20, v20 row_ror:1 row_mask:0xf bank_mask:0xf
    v_add_f32_dpp v22, v22, v22 row_ror:1 row_mask:0xf bank_mask:0xf
    v_add_f32_dpp v24, v24, v24 row_ror:1 row_mask:0xf bank_mask:0xf
    v_add_f32_dpp v26, v26, v26 row_ror:1 row_mask:0xf bank_mask:0xf
    v_cvt_pk_bf16_f32 v44, v20, v22
    v_lshlrev_b32 v20, 16, v44
    v_and_b32 v22, 0xffff0000, v44
    v_cvt_pk_bf16_f32 v45, v24, v26
    v_lshlrev_b32 v24, 16, v45
    v_and_b32 v26, 0xffff0000, v45
    v_max3_f32 v19, v20, v22, v24
    v_max_f32 v19, v19, v26
    v_mov_b32 v44, v19
    s_nop 1
    v_permlane16_swap_b32 v19, v44
    v_max_f32 v19, v19, v44
    v_mov_b32 v44, v19
    s_nop 1
    v_permlane32_swap_b32 v19, v44
    v_max_f32 v19, v19, v44
    v_mul_f32 v19, s97, v19
    v_max_f32 v19, v19, v17
    v_sub_f32 v18, v17, v19
    v_mov_b32 v17, v19
    v_exp_f32 v18, v18
    v_fma_f32 v20, v20, s97, -v17
    v_fma_f32 v22, v22, s97, -v17
    v_fma_f32 v24, v24, s97, -v17
    v_fma_f32 v26, v26, s97, -v17
    v_exp_f32 v20, v20
    v_exp_f32 v22, v22
    v_exp_f32 v24, v24
    v_exp_f32 v26, v26
    v_add_f32 v44, v20, v22
    v_add_f32 v45, v24, v26
    v_add_f32 v44, v44, v45
    v_fma_f32 v16, v16, v18, v44
    v_mul_f32 v8, v8, v18
    v_mul_f32 v9, v9, v18
    v_mul_f32 v10, v10, v18
    v_mul_f32 v11, v11, v18
    v_mul_f32 v12, v12, v18
    v_mul_f32 v13, v13, v18
    v_mul_f32 v14, v14, v18
    v_mul_f32 v15, v15, v18
    v_cvt_pk_bf16_f32 v28, v20, 0
    v_cvt_pk_bf16_f32 v30, v22, 0
    v_cvt_pk_bf16_f32 v32, v24, 0
    v_cvt_pk_bf16_f32 v34, v26, 0
    v_mov_b32 v29, v28
    v_mov_b32 v31, v30
    v_mov_b32 v33, v32
    v_mov_b32 v35, v34
    v_permlane16_swap_b32 v28, v29
    v_permlane16_swap_b32 v30, v31
    v_permlane16_swap_b32 v32, v33
    v_permlane16_swap_b32 v34, v35
    v_lshlrev_b32 v36, 16, v28
    v_lshlrev_b32 v37, 16, v29
    v_lshlrev_b32 v38, 16, v30
    v_lshlrev_b32 v39, 16, v31
    v_lshlrev_b32 v40, 16, v32
    v_lshlrev_b32 v41, 16, v33
    v_lshlrev_b32 v42, 16, v34
    v_lshlrev_b32 v43, 16, v35
    v_dot2c_f32_bf16 v8, v144, v28
    v_dot2c_f32_bf16 v9, v144, v36
    v_dot2c_f32_bf16 v10, v145, v28
    v_dot2c_f32_bf16 v11, v145, v36
    v_dot2c_f32_bf16 v12, v146, v28
    v_dot2c_f32_bf16 v13, v146, v36
    v_dot2c_f32_bf16 v14, v147, v28
    v_dot2c_f32_bf16 v15, v147, v36
    v_dot2c_f32_bf16 v8, v148, v29
    v_dot2c_f32_bf16 v9, v148, v37
    v_dot2c_f32_bf16 v10, v149, v29
    v_dot2c_f32_bf16 v11, v149, v37
    v_dot2c_f32_bf16 v12, v150, v29
    v_dot2c_f32_bf16 v13, v150, v37
    v_dot2c_f32_bf16 v14, v151, v29
    v_dot2c_f32_bf16 v15, v151, v37
    v_dot2c_f32_bf16 v8, v152, v30
    v_dot2c_f32_bf16 v9, v152, v38
    v_dot2c_f32_bf16 v10, v153, v30
    v_dot2c_f32_bf16 v11, v153, v38
    v_dot2c_f32_bf16 v12, v154, v30
    v_dot2c_f32_bf16 v13, v154, v38
    v_dot2c_f32_bf16 v14, v155, v30
    v_dot2c_f32_bf16 v15, v155, v38
    v_dot2c_f32_bf16 v8, v156, v31
    v_dot2c_f32_bf16 v9, v156, v39
    v_dot2c_f32_bf16 v10, v157, v31
    v_dot2c_f32_bf16 v11, v157, v39
    v_dot2c_f32_bf16 v12, v158, v31
    v_dot2c_f32_bf16 v13, v158, v39
    v_dot2c_f32_bf16 v14, v159, v31
    v_dot2c_f32_bf16 v15, v159, v39
    v_dot2c_f32_bf16 v8, v160, v32
    v_dot2c_f32_bf16 v9, v160, v40
    v_dot2c_f32_bf16 v10, v161, v32
    v_dot2c_f32_bf16 v11, v161, v40
    v_dot2c_f32_bf16 v12, v162, v32
    v_dot2c_f32_bf16 v13, v162, v40
    v_dot2c_f32_bf16 v14, v163, v32
    v_dot2c_f32_bf16 v15, v163, v40
    v_dot2c_f32_bf16 v8, v164, v33
    v_dot2c_f32_bf16 v9, v164, v41
    v_dot2c_f32_bf16 v10, v165, v33
    v_dot2c_f32_bf16 v11, v165, v41
    v_dot2c_f32_bf16 v12, v166, v33
    v_dot2c_f32_bf16 v13, v166, v41
    v_dot2c_f32_bf16 v14, v167, v33
    v_dot2c_f32_bf16 v15, v167, v41
    v_dot2c_f32_bf16 v8, v168, v34
    v_dot2c_f32_bf16 v9, v168, v42
    v_dot2c_f32_bf16 v10, v169, v34
    v_dot2c_f32_bf16 v11, v169, v42
    v_dot2c_f32_bf16 v12, v170, v34
    v_dot2c_f32_bf16 v13, v170, v42
    v_dot2c_f32_bf16 v14, v171, v34
    v_dot2c_f32_bf16 v15, v171, v42
    v_dot2c_f32_bf16 v8, v172, v35
    v_dot2c_f32_bf16 v9, v172, v43
    v_dot2c_f32_bf16 v10, v173, v35
    v_dot2c_f32_bf16 v11, v173, v43
    v_dot2c_f32_bf16 v12, v174, v35
    v_dot2c_f32_bf16 v13, v174, v43
    v_dot2c_f32_bf16 v14, v175, v35
    v_dot2c_f32_bf16 v15, v175, v43
    s_add_u32 s54, s101, 2
    s_cmp_ge_u32 s54, s58
    s_cbranch_scc1 L_pc_next
    s_cmp_lt_u32 s54, 4
    s_cbranch_scc1 L_pcr_23
    s_lshl_b32 s55, s3, 2
    s_add_u32 s55, s55, 1744
    v_mov_b32 v44, s55
    s_mov_b32 s96, 0
L_pcw_24:
    ds_read_b32 v45, v44
    s_waitcnt lgkmcnt(0)
    v_readfirstlane_b32 s55, v45
    s_cmp_lg_u32 s55, 0
    s_cbranch_scc1 L_pcr_23
    s_add_u32 s96, s96, 1
    s_cmp_ge_u32 s96, 0x8000
    s_cbranch_scc1 L_pcr_23
    s_sleep 1
    s_branch L_pcw_24
L_pcr_23:
    ds_read_b128 v[112:115], v46 offset:0
    ds_read_b128 v[116:119], v46 offset:1024
    ds_read_b128 v[120:123], v46 offset:2048
    ds_read_b128 v[124:127], v46 offset:3072
    ds_read_b128 v[128:131], v46 offset:4096
    ds_read_b128 v[132:135], v46 offset:5120
    ds_read_b128 v[136:139], v46 offset:6144
    ds_read_b128 v[140:143], v46 offset:7168
    ds_read_b128 v[144:147], v46 offset:8192
    ds_read_b128 v[148:151], v46 offset:9216
    ds_read_b128 v[152:155], v46 offset:10240
    ds_read_b128 v[156:159], v46 offset:11264
    ds_read_b128 v[160:163], v46 offset:12288
    ds_read_b128 v[164:167], v46 offset:13312
    ds_read_b128 v[168:171], v46 offset:14336
    ds_read_b128 v[172:175], v46 offset:15360
    s_branch L_pc_next
L_pc_odd:
    v_dot2_f32_bf16 v20, v176, v4, 0
    v_dot2_f32_bf16 v20, v177, v5, v20
    v_dot2_f32_bf16 v20, v178, v6, v20
    v_dot2_f32_bf16 v20, v179, v7, v20
    v_dot2_f32_bf16 v21, v180, v4, 0
    v_dot2_f32_bf16 v21, v181, v5, v21
    v_dot2_f32_bf16 v21, v182, v6, v21
    v_dot2_f32_bf16 v21, v183, v7, v21
    v_dot2_f32_bf16 v22, v184, v4, 0
    v_dot2_f32_bf16 v22, v185, v5, v22
    v_dot2_f32_bf16 v22, v186, v6, v22
    v_dot2_f32_bf16 v22, v187, v7, v22
    v_dot2_f32_bf16 v23, v188, v4, 0
    v_dot2_f32_bf16 v23, v189, v5, v23
    v_dot2_f32_bf16 v23, v190, v6, v23
    v_dot2_f32_bf16 v23, v191, v7, v23
    v_dot2_f32_bf16 v24, v192, v4, 0
    v_dot2_f32_bf16 v24, v193, v5, v24
    v_dot2_f32_bf16 v24, v194, v6, v24
    v_dot2_f32_bf16 v24, v195, v7, v24
    v_dot2_f32_bf16 v25, v196, v4, 0
    v_dot2_f32_bf16 v25, v197, v5, v25
    v_dot2_f32_bf16 v25, v198, v6, v25
    v_dot2_f32_bf16 v25, v199, v7, v25
    v_dot2_f32_bf16 v26, v200, v4, 0
    v_dot2_f32_bf16 v26, v201, v5, v26
    v_dot2_f32_bf16 v26, v202, v6, v26
    v_dot2_f32_bf16 v26, v203, v7, v26
    v_dot2_f32_bf16 v27, v204, v4, 0
    v_dot2_f32_bf16 v27, v205, v5, v27
    v_dot2_f32_bf16 v27, v206, v6, v27
    v_dot2_f32_bf16 v27, v207, v7, v27
    v_permlane16_swap_b32 v20, v21
    v_permlane16_swap_b32 v22, v23
    v_permlane16_swap_b32 v24, v25
    v_permlane16_swap_b32 v26, v27
    v_add_f32 v20, v20, v21
    v_add_f32 v22, v22, v23
    v_add_f32 v24, v24, v25
    v_add_f32 v26, v26, v27
    v_add_f32_dpp v20, v20, v20 row_ror:8 row_mask:0xf bank_mask:0xf
    v_add_f32_dpp v22, v22, v22 row_ror:8 row_mask:0xf bank_mask:0xf
    v_add_f32_dpp v24, v24, v24 row_ror:8 row_mask:0xf bank_mask:0xf
    v_add_f32_dpp v26, v26, v26 row_ror:8 row_mask:0xf bank_mask:0xf
    v_add_f32_dpp v20, v20, v20 row_ror:4 row_mask:0xf bank_mask:0xf
    v_add_f32_dpp v22, v22, v22 row_ror:4 row_mask:0xf bank_mask:0xf
    v_add_f32_dpp v24, v24, v24 row_ror:4 row_mask:0xf bank_mask:0xf
    v_add_f32_dpp v26, v26, v26 row_ror:4 row_mask:0xf bank_mask:0xf
    v_add_f32_dpp v20, v20, v20 row_ror:2 row_mask:0xf bank_mask:0xf
    v_add_f32_dpp v22, v22, v22 row_ror:2 row_mask:0xf bank_mask:0xf
    v_add_f32_dpp v24, v24, v24 row_ror:2 row_mask:0xf bank_mask:0xf
    v_add_f32_dpp v26, v26, v26 row_ror:2 row_mask:0xf bank_mask:0xf
    v_add_f32_dpp v20, v20, v20 row_ror:1 row_mask:0xf bank_mask:0xf
    v_add_f32_dpp v22, v22, v22 row_ror:1 row_mask:0xf bank_mask:0xf
    v_add_f32_dpp v24, v24, v24 row_ror:1 row_mask:0xf bank_mask:0xf
    v_add_f32_dpp v26, v26, v26 row_ror:1 row_mask:0xf bank_mask:0xf
    v_cvt_pk_bf16_f32 v44, v20, v22
    v_lshlrev_b32 v20, 16, v44
    v_and_b32 v22, 0xffff0000, v44
    v_cvt_pk_bf16_f32 v45, v24, v26
    v_lshlrev_b32 v24, 16, v45
    v_and_b32 v26, 0xffff0000, v45
    v_max3_f32 v19, v20, v22, v24
    v_max_f32 v19, v19, v26
    v_mov_b32 v44, v19
    s_nop 1
    v_permlane16_swap_b32 v19, v44
    v_max_f32 v19, v19, v44
    v_mov_b32 v44, v19
    s_nop 1
    v_permlane32_swap_b32 v19, v44
    v_max_f32 v19, v19, v44
    v_mul_f32 v19, s97, v19
    v_max_f32 v19, v19, v17
    v_sub_f32 v18, v17, v19
    v_mov_b32 v17, v19
    v_exp_f32 v18, v18
    v_fma_f32 v20, v20, s97, -v17
    v_fma_f32 v22, v22, s97, -v17
    v_fma_f32 v24, v24, s97, -v17
    v_fma_f32 v26, v26, s97, -v17
    v_exp_f32 v20, v20
    v_exp_f32 v22, v22
    v_exp_f32 v24, v24
    v_exp_f32 v26, v26
    v_add_f32 v44, v20, v22
    v_add_f32 v45, v24, v26
    v_add_f32 v44, v44, v45
    v_fma_f32 v16, v16, v18, v44
    v_mul_f32 v8, v8, v18
    v_mul_f32 v9, v9, v18
    v_mul_f32 v10, v10, v18
    v_mul_f32 v11, v11, v18
    v_mul_f32 v12, v12, v18
    v_mul_f32 v13, v13, v18
    v_mul_f32 v14, v14, v18
    v_mul_f32 v15, v15, v18
    v_cvt_pk_bf16_f32 v28, v20, 0
    v_cvt_pk_bf16_f32 v30, v22, 0
    v_cvt_pk_bf16_f32 v32, v24, 0
    v_cvt_pk_bf16_f32 v34, v26, 0
    v_mov_b32 v29, v28
    v_mov_b32 v31, v30
    v_mov_b32 v33, v32
    v_mov_b32 v35, v34
    v_permlane16_swap_b32 v28, v29
    v_permlane16_swap_b32 v30, v31
    v_permlane16_swap_b32 v32, v33
    v_permlane16_swap_b32 v34, v35
    v_lshlrev_b32 v36, 16, v28
    v_lshlrev_b32 v37, 16, v29
    v_lshlrev_b32 v38, 16, v30
    v_lshlrev_b32 v39, 16, v31
    v_lshlrev_b32 v40, 16, v32
    v_lshlrev_b32 v41, 16, v33
    v_lshlrev_b32 v42, 16, v34
    v_lshlrev_b32 v43, 16, v35
    v_dot2c_f32_bf16 v8, v208, v28
    v_dot2c_f32_bf16 v9, v208, v36
    v_dot2c_f32_bf16 v10, v209, v28
    v_dot2c_f32_bf16 v11, v209, v36
    v_dot2c_f32_bf16 v12, v210, v28
    v_dot2c_f32_bf16 v13, v210, v36
    v_dot2c_f32_bf16 v14, v211, v28
    v_dot2c_f32_bf16 v15, v211, v36
    v_dot2c_f32_bf16 v8, v212, v29
    v_dot2c_f32_bf16 v9, v212, v37
    v_dot2c_f32_bf16 v10, v213, v29
    v_dot2c_f32_bf16 v11, v213, v37
    v_dot2c_f32_bf16 v12, v214, v29
    v_dot2c_f32_bf16 v13, v214, v37
    v_dot2c_f32_bf16 v14, v215, v29
    v_dot2c_f32_bf16 v15, v215, v37
    v_dot2c_f32_bf16 v8, v216, v30
    v_dot2c_f32_bf16 v9, v216, v38
    v_dot2c_f32_bf16 v10, v217, v30
    v_dot2c_f32_bf16 v11, v217, v38
    v_dot2c_f32_bf16 v12, v218, v30
    v_dot2c_f32_bf16 v13, v218, v38
    v_dot2c_f32_bf16 v14, v219, v30
    v_dot2c_f32_bf16 v15, v219, v38
    v_dot2c_f32_bf16 v8, v220, v31
    v_dot2c_f32_bf16 v9, v220, v39
    v_dot2c_f32_bf16 v10, v221, v31
    v_dot2c_f32_bf16 v11, v221, v39
    v_dot2c_f32_bf16 v12, v222, v31
    v_dot2c_f32_bf16 v13, v222, v39
    v_dot2c_f32_bf16 v14, v223, v31
    v_dot2c_f32_bf16 v15, v223, v39
    v_dot2c_f32_bf16 v8, v224, v32
    v_dot2c_f32_bf16 v9, v224, v40
    v_dot2c_f32_bf16 v10, v225, v32
    v_dot2c_f32_bf16 v11, v225, v40
    v_dot2c_f32_bf16 v12, v226, v32
    v_dot2c_f32_bf16 v13, v226, v40
    v_dot2c_f32_bf16 v14, v227, v32
    v_dot2c_f32_bf16 v15, v227, v40
    v_dot2c_f32_bf16 v8, v228, v33
    v_dot2c_f32_bf16 v9, v228, v41
    v_dot2c_f32_bf16 v10, v229, v33
    v_dot2c_f32_bf16 v11, v229, v41
    v_dot2c_f32_bf16 v12, v230, v33
    v_dot2c_f32_bf16 v13, v230, v41
    v_dot2c_f32_bf16 v14, v231, v33
    v_dot2c_f32_bf16 v15, v231, v41
    v_dot2c_f32_bf16 v8, v232, v34
    v_dot2c_f32_bf16 v9, v232, v42
    v_dot2c_f32_bf16 v10, v233, v34
    v_dot2c_f32_bf16 v11, v233, v42
    v_dot2c_f32_bf16 v12, v234, v34
    v_dot2c_f32_bf16 v13, v234, v42
    v_dot2c_f32_bf16 v14, v235, v34
    v_dot2c_f32_bf16 v15, v235, v42
    v_dot2c_f32_bf16 v8, v236, v35
    v_dot2c_f32_bf16 v9, v236, v43
    v_dot2c_f32_bf16 v10, v237, v35
    v_dot2c_f32_bf16 v11, v237, v43
    v_dot2c_f32_bf16 v12, v238, v35
    v_dot2c_f32_bf16 v13, v238, v43
    v_dot2c_f32_bf16 v14, v239, v35
    v_dot2c_f32_bf16 v15, v239, v43
    s_add_u32 s54, s101, 2
    s_cmp_ge_u32 s54, s58
    s_cbranch_scc1 L_pc_next
    s_cmp_lt_u32 s54, 4
    s_cbranch_scc1 L_pcr_26
    s_lshl_b32 s55, s3, 2
    s_add_u32 s55, s55, 1744
    v_mov_b32 v44, s55
    s_mov_b32 s96, 0
L_pcw_27:
    ds_read_b32 v45, v44
    s_waitcnt lgkmcnt(0)
    v_readfirstlane_b32 s55, v45
    s_cmp_lg_u32 s55, 0
    s_cbranch_scc1 L_pcr_26
    s_add_u32 s96, s96, 1
    s_cmp_ge_u32 s96, 0x8000
    s_cbranch_scc1 L_pcr_26
    s_sleep 1
    s_branch L_pcw_27
L_pcr_26:
    ds_read_b128 v[176:179], v46 offset:16384
    ds_read_b128 v[180:183], v46 offset:17408
    ds_read_b128 v[184:187], v46 offset:18432
    ds_read_b128 v[188:191], v46 offset:19456
    ds_read_b128 v[192:195], v46 offset:20480
    ds_read_b128 v[196:199], v46 offset:21504
    ds_read_b128 v[200:203], v46 offset:22528
    ds_read_b128 v[204:207], v46 offset:23552
    ds_read_b128 v[208:211], v46 offset:24576
    ds_read_b128 v[212:215], v46 offset:25600
    ds_read_b128 v[216:219], v46 offset:26624
    ds_read_b128 v[220:223], v46 offset:27648
    ds_read_b128 v[224:227], v46 offset:28672
    ds_read_b128 v[228:231], v46 offset:29696
    ds_read_b128 v[232:235], v46 offset:30720
    ds_read_b128 v[236:239], v46 offset:31744
    s_cmp_lg_u32 s101, 1
    s_cbranch_scc1 L_pc_next
    s_waitcnt lgkmcnt(0)
    s_lshl_b32 s55, s3, 2
    s_add_u32 s55, s55, 1728
    v_mov_b32 v44, s55
    v_mov_b32 v45, 1
    s_mov_b64 exec, 1
    ds_write_b32 v44, v45
    s_mov_b64 exec, -1
L_pc_next:
    s_add_u32 s101, s101, 1
    s_cmp_lt_u32 s101, s58
    s_cbranch_scc1 L_back
    s_waitcnt lgkmcnt(0)
    s_waitcnt lgkmcnt(0)
    v_mov_b32 v44, 20
    v_mov_b32 v45, 1
    s_mov_b64 exec, 1
    ds_add_u32 v44, v45
    s_mov_b64 exec, -1
    s_branch L_back
L_helper:
    s_setprio 3
    s_sub_u32 s35, s3, 4
    s_mov_b32 s48, s4
    s_mov_b32 s49, s5
    s_mov_b32 s50, 0x1c00
    s_mov_b32 s51, 0x00020000
    s_cmp_ge_u32 s15, 14
    s_cbranch_scc1 L_noA
    s_mov_b32 s44, s22
    s_mov_b32 s45, s23
    s_mov_b32 s46, 0x1c00
    s_mov_b32 s47, 0x00020000
    s_lshl_b32 s54, s35, 10
    v_lshlrev_b32 v8, 4, v1
    v_add_u32 v8, s54, v8
    buffer_load_dwordx4 v[16:19], v8, s[44:47], 0 offen
    s_mov_b32 s55, 4096
    buffer_load_dwordx4 v[20:23], v8, s[44:47], s55 offen
    v_mov_b32 v56, 0
    v_mov_b32 v57, 0
    v_mov_b32 v58, 0
    v_mov_b32 v59, 0
    v_mov_b32 v60, 0
    v_mov_b32 v61, 0
    v_mov_b32 v62, 0
    v_mov_b32 v63, 0
    v_lshlrev_b32 v9, 4, v1
    s_mul_i32 s55, s35, 896
    s_mov_b32 exec_lo, -1
    s_mov_b32 exec_hi, 0x00ffffff
    buffer_load_dwordx4 v[56:59], v9, s[48:51], s55 offen
    buffer_load_dwordx4 v[60:63], v9, s[48:51], s55 offen offset:3584
    s_mov_b64 exec, -1
    v_bfe_u32 v10, v1, 4, 1
    v_mul_u32_u24 v10, 3584, v10
    v_and_b32 v3, 15, v1
    v_lshl_add_u32 v10, v3, 2, v10
    s_mul_i32 s55, s35, 896
    s_lshl_b32 s56, s15, 6
    s_add_u32 s55, s55, s56
    buffer_load_dword v64, v10, s[48:51], s55 offen
    s_mov_b32 s40, s24
    s_mov_b32 s41, s25
    s_mov_b32 s42, 0x24c000
    s_mov_b32 s43, 0x00020000
    v_lshrrev_b32 v2, 4, v1
    v_mul_u32_u24 v2, 43008, v2
    v_lshl_add_u32 v2, v3, 2, v2
    s_and_b32 s57, s35, 1
    s_mul_i32 s57, s57, 896
    s_add_u32 s56, s56, s57
    s_lshr_b32 s57, s35, 1
    s_mul_i32 s57, s57, 1204224
    s_add_u32 s56, s56, s57
    buffer_load_dword v72, v2, s[40:43], s56 offen
    s_add_u32 s56, s56, 5376
    buffer_load_dword v73, v2, s[40:43], s56 offen
    s_add_u32 s56, s56, 5376
    buffer_load_dword v74, v2, s[40:43], s56 offen
    s_add_u32 s56, s56, 5376
    buffer_load_dword v75, v2, s[40:43], s56 offen
    s_add_u32 s56, s56, 5376
    buffer_load_dword v76, v2, s[40:43], s56 offen
    s_add_u32 s56, s56, 5376
    buffer_load_dword v77, v2, s[40:43], s56 offen
    s_add_u32 s56, s56, 5376
    buffer_load_dword v78, v2, s[40:43], s56 offen
    s_add_u32 s56, s56, 5376
    buffer_load_dword v79, v2, s[40:43], s56 offen
    s_add_u32 s56, s56, 5376
    s_add_u32 s56, s56, 129024
    buffer_load_dword v80, v2, s[40:43], s56 offen
    s_add_u32 s56, s56, 5376
    buffer_load_dword v81, v2, s[40:43], s56 offen
    s_add_u32 s56, s56, 5376
    buffer_load_dword v82, v2, s[40:43], s56 offen
    s_add_u32 s56, s56, 5376
    buffer_load_dword v83, v2, s[40:43], s56 offen
    s_add_u32 s56, s56, 5376
    buffer_load_dword v84, v2, s[40:43], s56 offen
    s_add_u32 s56, s56, 5376
    buffer_load_dword v85, v2, s[40:43], s56 offen
    s_add_u32 s56, s56, 5376
    buffer_load_dword v86, v2, s[40:43], s56 offen
    s_add_u32 s56, s56, 5376
    buffer_load_dword v87, v2, s[40:43], s56 offen
    s_add_u32 s56, s56, 5376
    s_add_u32 s56, s56, 129024
    buffer_load_dword v88, v2, s[40:43], s56 offen
    s_add_u32 s56, s56, 5376
    buffer_load_dword v89, v2, s[40:43], s56 offen
    s_add_u32 s56, s56, 5376
    buffer_load_dword v90, v2, s[40:43], s56 offen
    s_add_u32 s56, s56, 5376
    buffer_load_dword v91, v2, s[40:43], s56 offen
    s_add_u32 s56, s56, 5376
    buffer_load_dword v92, v2, s[40:43], s56 offen
    s_add_u32 s56, s56, 5376
    buffer_load_dword v93, v2, s[40:43], s56 offen
    s_add_u32 s56, s56, 5376
    buffer_load_dword v94, v2, s[40:43], s56 offen
    s_add_u32 s56, s56, 5376
    buffer_load_dword v95, v2, s[40:43], s56 offen
    s_add_u32 s56, s56, 5376
    s_add_u32 s56, s56, 129024
    buffer_load_dword v96, v2, s[40:43], s56 offen
    s_add_u32 s56, s56, 5376
    buffer_load_dword v97, v2, s[40:43], s56 offen
    s_add_u32 s56, s56, 5376
    buffer_load_dword v98, v2, s[40:43], s56 offen
    s_add_u32 s56, s56, 5376
    buffer_load_dword v99, v2, s[40:43], s56 offen
    s_add_u32 s56, s56, 5376
    buffer_load_dword v100, v2, s[40:43], s56 offen
    s_add_u32 s56, s56, 5376
    buffer_load_dword v101, v2, s[40:43], s56 offen
    s_add_u32 s56, s56, 5376
    buffer_load_dword v102, v2, s[40:43], s56 offen
    s_add_u32 s56, s56, 5376
    buffer_load_dword v103, v2, s[40:43], s56 offen
    s_add_u32 s56, s56, 5376
    s_add_u32 s56, s56, 129024
    buffer_load_dword v104, v2, s[40:43], s56 offen
    s_add_u32 s56, s56, 5376
    buffer_load_dword v105, v2, s[40:43], s56 offen
    s_add_u32 s56, s56, 5376
    buffer_load_dword v106, v2, s[40:43], s56 offen
    s_add_u32 s56, s56, 5376
    buffer_load_dword v107, v2, s[40:43], s56 offen
    s_add_u32 s56, s56, 5376
    buffer_load_dword v108, v2, s[40:43], s56 offen
    s_add_u32 s56, s56, 5376
    buffer_load_dword v109, v2, s[40:43], s56 offen
    s_add_u32 s56, s56, 5376
    buffer_load_dword v110, v2, s[40:43], s56 offen
    s_add_u32 s56, s56, 5376
    buffer_load_dword v111, v2, s[40:43], s56 offen
    s_add_u32 s56, s56, 5376
    s_add_u32 s56, s56, 129024
    buffer_load_dword v112, v2, s[40:43], s56 offen
    s_add_u32 s56, s56, 5376
    buffer_load_dword v113, v2, s[40:43], s56 offen
    s_add_u32 s56, s56, 5376
    buffer_load_dword v114, v2, s[40:43], s56 offen
    s_add_u32 s56, s56, 5376
    buffer_load_dword v115, v2, s[40:43], s56 offen
    s_add_u32 s56, s56, 5376
    buffer_load_dword v116, v2, s[40:43], s56 offen
    s_add_u32 s56, s56, 5376
    buffer_load_dword v117, v2, s[40:43], s56 offen
    s_add_u32 s56, s56, 5376
    buffer_load_dword v118, v2, s[40:43], s56 offen
    s_add_u32 s56, s56, 5376
    buffer_load_dword v119, v2, s[40:43], s56 offen
    s_add_u32 s56, s56, 5376
    s_add_u32 s56, s56, 129024
    buffer_load_dword v120, v2, s[40:43], s56 offen
    s_add_u32 s56, s56, 5376
    buffer_load_dword v121, v2, s[40:43], s56 offen
    s_add_u32 s56, s56, 5376
    buffer_load_dword v122, v2, s[40:43], s56 offen
    s_add_u32 s56, s56, 5376
    buffer_load_dword v123, v2, s[40:43], s56 offen
    s_add_u32 s56, s56, 5376
    buffer_load_dword v124, v2, s[40:43], s56 offen
    s_add_u32 s56, s56, 5376
    buffer_load_dword v125, v2, s[40:43], s56 offen
    s_add_u32 s56, s56, 5376
    buffer_load_dword v126, v2, s[40:43], s56 offen
    s_add_u32 s56, s56, 5376
    buffer_load_dword v127, v2, s[40:43], s56 offen
    s_add_u32 s56, s56, 5376
    s_add_u32 s56, s56, 129024
    s_waitcnt lgkmcnt(0)
    v_mov_b32 v9, 32
    v_mov_b32 v10, 1
    s_mov_b64 exec, 1
    ds_add_u32 v9, v10
    s_mov_b64 exec, -1
    s_waitcnt vmcnt(59)
    v_lshlrev_b32 v24, 16, v16
    v_and_b32 v25, 0xffff0000, v16
    v_lshlrev_b32 v26, 16, v17
    v_and_b32 v27, 0xffff0000, v17
    v_lshlrev_b32 v28, 16, v18
    v_and_b32 v29, 0xffff0000, v18
    v_lshlrev_b32 v30, 16, v19
    v_and_b32 v31, 0xffff0000, v19
    v_lshlrev_b32 v32, 16, v20
    v_and_b32 v33, 0xffff0000, v20
    v_lshlrev_b32 v34, 16, v21
    v_and_b32 v35, 0xffff0000, v21
    v_lshlrev_b32 v36, 16, v22
    v_and_b32 v37, 0xffff0000, v22
    v_lshlrev_b32 v38, 16, v23
    v_and_b32 v39, 0xffff0000, v23
    v_mul_f32 v40, 0xbfb8aa3b, v24
    v_mul_f32 v41, 0xbfb8aa3b, v25
    v_mul_f32 v42, 0xbfb8aa3b, v26
    v_mul_f32 v43, 0xbfb8aa3b, v27
    v_mul_f32 v44, 0xbfb8aa3b, v28
    v_mul_f32 v45, 0xbfb8aa3b, v29
    v_mul_f32 v46, 0xbfb8aa3b, v30
    v_mul_f32 v47, 0xbfb8aa3b, v31
    v_mul_f32 v48, 0xbfb8aa3b, v32
    v_mul_f32 v49, 0xbfb8aa3b, v33
    v_mul_f32 v50, 0xbfb8aa3b, v34
    v_mul_f32 v51, 0xbfb8aa3b, v35
    v_mul_f32 v52, 0xbfb8aa3b, v36
    v_mul_f32 v53, 0xbfb8aa3b, v37
    v_mul_f32 v54, 0xbfb8aa3b, v38
    v_mul_f32 v55, 0xbfb8aa3b, v39
    v_exp_f32 v40, v40
    v_exp_f32 v41, v41
    v_exp_f32 v42, v42
    v_exp_f32 v43, v43
    v_exp_f32 v44, v44
    v_exp_f32 v45, v45
    v_exp_f32 v46, v46
    v_exp_f32 v47, v47
    v_exp_f32 v48, v48
    v_exp_f32 v49, v49
    v_exp_f32 v50, v50
    v_exp_f32 v51, v51
    v_exp_f32 v52, v52
    v_exp_f32 v53, v53
    v_exp_f32 v54, v54
    v_exp_f32 v55, v55
    v_add_f32 v40, 1.0, v40
    v_add_f32 v41, 1.0, v41
    v_add_f32 v42, 1.0, v42
    v_add_f32 v43, 1.0, v43
    v_add_f32 v44, 1.0, v44
    v_add_f32 v45, 1.0, v45
    v_add_f32 v46, 1.0, v46
    v_add_f32 v47, 1.0, v47
    v_add_f32 v48, 1.0, v48
    v_add_f32 v49, 1.0, v49
    v_add_f32 v50, 1.0, v50
    v_add_f32 v51, 1.0, v51
    v_add_f32 v52, 1.0, v52
    v_add_f32 v53, 1.0, v53
    v_add_f32 v54, 1.0, v54
    v_add_f32 v55, 1.0, v55
    v_rcp_f32 v40, v40
    v_rcp_f32 v41, v41
    v_rcp_f32 v42, v42
    v_rcp_f32 v43, v43
    v_rcp_f32 v44, v44
    v_rcp_f32 v45, v45
    v_rcp_f32 v46, v46
    v_rcp_f32 v47, v47
    v_rcp_f32 v48, v48
    v_rcp_f32 v49, v49
    v_rcp_f32 v50, v50
    v_rcp_f32 v51, v51
    v_rcp_f32 v52, v52
    v_rcp_f32 v53, v53
    v_rcp_f32 v54, v54
    v_rcp_f32 v55, v55
    v_mul_f32 v24, v24, v40
    v_mul_f32 v25, v25, v41
    v_mul_f32 v26, v26, v42
    v_mul_f32 v27, v27, v43
    v_mul_f32 v28, v28, v44
    v_mul_f32 v29, v29, v45
    v_mul_f32 v30, v30, v46
    v_mul_f32 v31, v31, v47
    v_mul_f32 v32, v32, v48
    v_mul_f32 v33, v33, v49
    v_mul_f32 v34, v34, v50
    v_mul_f32 v35, v35, v51
    v_mul_f32 v36, v36, v52
    v_mul_f32 v37, v37, v53
    v_mul_f32 v38, v38, v54
    v_mul_f32 v39, v39, v55
    v_cvt_pk_bf16_f32 v16, v24, v25
    v_cvt_pk_bf16_f32 v17, v26, v27
    v_cvt_pk_bf16_f32 v18, v28, v29
    v_cvt_pk_bf16_f32 v19, v30, v31
    v_cvt_pk_bf16_f32 v20, v32, v33
    v_cvt_pk_bf16_f32 v21, v34, v35
    v_cvt_pk_bf16_f32 v22, v36, v37
    v_cvt_pk_bf16_f32 v23, v38, v39
    ds_write_b128 v8, v[16:19] offset:16640
    s_cmp_eq_u32 s35, 3
    s_cbranch_scc1 L_si_28
    ds_write_b128 v8, v[20:23] offset:20736
L_si_28:
    s_waitcnt lgkmcnt(0)
    v_mov_b32 v9, 4
    v_mov_b32 v10, 1
    s_mov_b64 exec, 1
    ds_add_u32 v9, v10
    s_mov_b64 exec, -1
    s_waitcnt vmcnt(57)
    v_lshlrev_b32 v16, 16, v56
    v_and_b32 v17, 0xffff0000, v56
    v_lshlrev_b32 v18, 16, v57
    v_and_b32 v19, 0xffff0000, v57
    v_lshlrev_b32 v20, 16, v58
    v_and_b32 v21, 0xffff0000, v58
    v_lshlrev_b32 v22, 16, v59
    v_and_b32 v23, 0xffff0000, v59
    v_lshlrev_b32 v24, 16, v60
    v_and_b32 v25, 0xffff0000, v60
    v_lshlrev_b32 v26, 16, v61
    v_and_b32 v27, 0xffff0000, v61
    v_lshlrev_b32 v28, 16, v62
    v_and_b32 v29, 0xffff0000, v62
    v_lshlrev_b32 v30, 16, v63
    v_and_b32 v31, 0xffff0000, v63
    v_add_f32 v32, v16, v17
    v_add_f32 v38, v24, v25
    v_add_f32 v32, v32, v18
    v_add_f32 v38, v38, v26
    v_add_f32 v32, v32, v19
    v_add_f32 v38, v38, v27
    v_add_f32 v32, v32, v20
    v_add_f32 v38, v38, v28
    v_add_f32 v32, v32, v21
    v_add_f32 v38, v38, v29
    v_add_f32 v32, v32, v22
    v_add_f32 v38, v38, v30
    v_add_f32 v32, v32, v23
    v_add_f32 v38, v38, v31
    s_nop 0
    v_add_f32_dpp v32, v32, v32 row_ror:8 row_mask:0xf bank_mask:0xf
    v_add_f32_dpp v38, v38, v38 row_ror:8 row_mask:0xf bank_mask:0xf
    s_nop 0
    v_add_f32_dpp v32, v32, v32 row_ror:4 row_mask:0xf bank_mask:0xf
    v_add_f32_dpp v38, v38, v38 row_ror:4 row_mask:0xf bank_mask:0xf
    s_nop 0
    v_add_f32_dpp v32, v32, v32 row_ror:2 row_mask:0xf bank_mask:0xf
    v_add_f32_dpp v38, v38, v38 row_ror:2 row_mask:0xf bank_mask:0xf
    s_nop 0
    v_add_f32_dpp v32, v32, v32 row_ror:1 row_mask:0xf bank_mask:0xf
    v_add_f32_dpp v38, v38, v38 row_ror:1 row_mask:0xf bank_mask:0xf
    v_mov_b32 v33, v32
    v_mov_b32 v39, v38
    s_nop 0
    v_permlane16_swap_b32 v32, v33
    v_permlane16_swap_b32 v38, v39
    v_add_f32 v32, v32, v33
    v_add_f32 v38, v38, v39
    v_mov_b32 v33, v32
    v_mov_b32 v39, v38
    s_nop 0
    v_permlane32_swap_b32 v32, v33
    v_permlane32_swap_b32 v38, v39
    v_add_f32 v32, v32, v33
    v_add_f32 v38, v38, v39
    v_mul_f32 v32, 0x3b124925, v32
    v_mul_f32 v38, 0x3b124925, v38
    v_sub_f32 v35, v16, v32
    v_sub_f32 v41, v24, v38
    v_mul_f32 v34, v35, v35
    v_mul_f32 v40, v41, v41
    v_sub_f32 v35, v17, v32
    v_sub_f32 v41, v25, v38
    v_fmac_f32 v34, v35, v35
    v_fmac_f32 v40, v41, v41
    v_sub_f32 v35, v18, v32
    v_sub_f32 v41, v26, v38
    v_fmac_f32 v34, v35, v35
    v_fmac_f32 v40, v41, v41
    v_sub_f32 v35, v19, v32
    v_sub_f32 v41, v27, v38
    v_fmac_f32 v34, v35, v35
    v_fmac_f32 v40, v41, v41
    v_sub_f32 v35, v20, v32
    v_sub_f32 v41, v28, v38
    v_fmac_f32 v34, v35, v35
    v_fmac_f32 v40, v41, v41
    v_sub_f32 v35, v21, v32
    v_sub_f32 v41, v29, v38
    v_fmac_f32 v34, v35, v35
    v_fmac_f32 v40, v41, v41
    v_sub_f32 v35, v22, v32
    v_sub_f32 v41, v30, v38
    v_fmac_f32 v34, v35, v35
    v_fmac_f32 v40, v41, v41
    v_sub_f32 v35, v23, v32
    v_sub_f32 v41, v31, v38
    v_fmac_f32 v34, v35, v35
    v_fmac_f32 v40, v41, v41
    s_mov_b32 s60, -1
    s_mov_b32 s61, 0x00ffffff
    v_cndmask_b32 v34, 0, v34, s[60:61]
    v_cndmask_b32 v40, 0, v40, s[60:61]
    s_nop 0
    v_add_f32_dpp v34, v34, v34 row_ror:8 row_mask:0xf bank_mask:0xf
    v_add_f32_dpp v40, v40, v40 row_ror:8 row_mask:0xf bank_mask:0xf
    s_nop 0
    v_add_f32_dpp v34, v34, v34 row_ror:4 row_mask:0xf bank_mask:0xf
    v_add_f32_dpp v40, v40, v40 row_ror:4 row_mask:0xf bank_mask:0xf
    s_nop 0
    v_add_f32_dpp v34, v34, v34 row_ror:2 row_mask:0xf bank_mask:0xf
    v_add_f32_dpp v40, v40, v40 row_ror:2 row_mask:0xf bank_mask:0xf
    s_nop 0
    v_add_f32_dpp v34, v34, v34 row_ror:1 row_mask:0xf bank_mask:0xf
    v_add_f32_dpp v40, v40, v40 row_ror:1 row_mask:0xf bank_mask:0xf
    v_mov_b32 v33, v34
    v_mov_b32 v39, v40
    s_nop 0
    v_permlane16_swap_b32 v34, v33
    v_permlane16_swap_b32 v40, v39
    v_add_f32 v34, v34, v33
    v_add_f32 v40, v40, v39
    v_mov_b32 v33, v34
    v_mov_b32 v39, v40
    s_nop 0
    v_permlane32_swap_b32 v34, v33
    v_permlane32_swap_b32 v40, v39
    v_add_f32 v34, v34, v33
    v_add_f32 v40, v40, v39
    v_mul_f32 v34, 0x3b124925, v34
    v_mul_f32 v40, 0x3b124925, v40
    v_mov_b32 v36, v32
    v_mov_b32 v42, v38
    v_cvt_pk_bf16_f32 v33, v36, v34
    v_lshlrev_b32 v36, 16, v33
    v_and_b32 v34, 0xffff0000, v33
    v_cvt_pk_bf16_f32 v39, v42, v40
    v_lshlrev_b32 v42, 16, v39
    v_and_b32 v40, 0xffff0000, v39
    v_add_f32 v34, 0x3727c5ac, v34
    v_add_f32 v40, 0x3727c5ac, v40
    v_cvt_pk_bf16_f32 v33, v34, v34
    v_lshlrev_b32 v34, 16, v33
    v_cvt_pk_bf16_f32 v39, v40, v40
    v_lshlrev_b32 v40, 16, v39
    v_sqrt_f32 v34, v34
    v_sqrt_f32 v40, v40
    v_cvt_pk_bf16_f32 v33, v34, v34
    v_lshlrev_b32 v34, 16, v33
    v_cvt_pk_bf16_f32 v39, v40, v40
    v_lshlrev_b32 v40, 16, v39
    v_rcp_f32 v37, v34
    v_rcp_f32 v43, v40
    v_cndmask_b32 v66, v36, v42, s[52:53]
    v_cndmask_b32 v67, v37, v43, s[52:53]
    v_mov_b32 v9, 4
    s_mov_b32 s96, 0
Lw_29:
    ds_read_b32 v10, v9
    s_waitcnt lgkmcnt(0)
    v_readfirstlane_b32 s54, v10
    s_cmp_ge_u32 s54, 4
    s_cbranch_scc1 Lwd_30
    s_add_u32 s96, s96, 1
    s_cmp_ge_u32 s96, 0x8000
    s_cbranch_scc1 Lwd_30
    s_branch Lw_29
Lwd_30:
    v_and_b32 v9, 7, v1
    v_mul_u32_u24 v9, 896, v9
    v_lshrrev_b32 v10, 4, v1
    v_lshl_add_u32 v9, v10, 4, v9
    s_lshr_b32 s54, s35, 1
    s_mul_i32 s54, s54, 448
    v_add_u32 v9, s54, v9
    ds_read_b128 v[184:187], v9 offset:16640
    ds_read_b128 v[188:191], v9 offset:16704
    ds_read_b128 v[192:195], v9 offset:16768
    ds_read_b128 v[196:199], v9 offset:16832
    ds_read_b128 v[200:203], v9 offset:16896
    ds_read_b128 v[204:207], v9 offset:16960
    ds_read_b128 v[208:211], v9 offset:17024
    s_waitcnt vmcnt(48)
    v_perm_b32 v128, v73, v72, s62
    v_perm_b32 v129, v75, v74, s62
    v_perm_b32 v130, v77, v76, s62
    v_perm_b32 v131, v79, v78, s62
    v_perm_b32 v132, v73, v72, s63
    v_perm_b32 v133, v75, v74, s63
    v_perm_b32 v134, v77, v76, s63
    v_perm_b32 v135, v79, v78, s63
    s_waitcnt vmcnt(40)
    v_perm_b32 v136, v81, v80, s62
    v_perm_b32 v137, v83, v82, s62
    v_perm_b32 v138, v85, v84, s62
    v_perm_b32 v139, v87, v86, s62
    v_perm_b32 v140, v81, v80, s63
    v_perm_b32 v141, v83, v82, s63
    v_perm_b32 v142, v85, v84, s63
    v_perm_b32 v143, v87, v86, s63
    s_waitcnt vmcnt(32)
    v_perm_b32 v144, v89, v88, s62
    v_perm_b32 v145, v91, v90, s62
    v_perm_b32 v146, v93, v92, s62
    v_perm_b32 v147, v95, v94, s62
    v_perm_b32 v148, v89, v88, s63
    v_perm_b32 v149, v91, v90, s63
    v_perm_b32 v150, v93, v92, s63
    v_perm_b32 v151, v95, v94, s63
    s_waitcnt vmcnt(24)
    v_perm_b32 v152, v97, v96, s62
    v_perm_b32 v153, v99, v98, s62
    v_perm_b32 v154, v101, v100, s62
    v_perm_b32 v155, v103, v102, s62
    v_perm_b32 v156, v97, v96, s63
    v_perm_b32 v157, v99, v98, s63
    v_perm_b32 v158, v101, v100, s63
    v_perm_b32 v159, v103, v102, s63
    s_waitcnt vmcnt(16)
    v_perm_b32 v160, v105, v104, s62
    v_perm_b32 v161, v107, v106, s62
    v_perm_b32 v162, v109, v108, s62
    v_perm_b32 v163, v111, v110, s62
    v_perm_b32 v164, v105, v104, s63
    v_perm_b32 v165, v107, v106, s63
    v_perm_b32 v166, v109, v108, s63
    v_perm_b32 v167, v111, v110, s63
    s_waitcnt vmcnt(8)
    v_perm_b32 v168, v113, v112, s62
    v_perm_b32 v169, v115, v114, s62
    v_perm_b32 v170, v117, v116, s62
    v_perm_b32 v171, v119, v118, s62
    v_perm_b32 v172, v113, v112, s63
    v_perm_b32 v173, v115, v114, s63
    v_perm_b32 v174, v117, v116, s63
    v_perm_b32 v175, v119, v118, s63
    s_waitcnt vmcnt(0)
    v_perm_b32 v176, v121, v120, s62
    v_perm_b32 v177, v123, v122, s62
    v_perm_b32 v178, v125, v124, s62
    v_perm_b32 v179, v127, v126, s62
    v_perm_b32 v180, v121, v120, s63
    v_perm_b32 v181, v123, v122, s63
    v_perm_b32 v182, v125, v124, s63
    v_perm_b32 v183, v127, v126, s63
    s_waitcnt lgkmcnt(0)
    v_mfma_f32_16x16x32_bf16 v[212:215], v[184:187], v[128:131], 0
    v_mfma_f32_16x16x32_bf16 v[216:219], v[184:187], v[132:135], 0
    v_mfma_f32_16x16x32_bf16 v[212:215], v[188:191], v[136:139], v[212:215]
    v_mfma_f32_16x16x32_bf16 v[216:219], v[188:191], v[140:143], v[216:219]
    v_mfma_f32_16x16x32_bf16 v[212:215], v[192:195], v[144:147], v[212:215]
    v_mfma_f32_16x16x32_bf16 v[216:219], v[192:195], v[148:151], v[216:219]
    v_mfma_f32_16x16x32_bf16 v[212:215], v[196:199], v[152:155], v[212:215]
    v_mfma_f32_16x16x32_bf16 v[216:219], v[196:199], v[156:159], v[216:219]
    v_mfma_f32_16x16x32_bf16 v[212:215], v[200:203], v[160:163], v[212:215]
    v_mfma_f32_16x16x32_bf16 v[216:219], v[200:203], v[164:167], v[216:219]
    v_mfma_f32_16x16x32_bf16 v[212:215], v[204:207], v[168:171], v[212:215]
    v_mfma_f32_16x16x32_bf16 v[216:219], v[204:207], v[172:175], v[216:219]
    v_mfma_f32_16x16x32_bf16 v[212:215], v[208:211], v[176:179], v[212:215]
    v_mfma_f32_16x16x32_bf16 v[216:219], v[208:211], v[180:183], v[216:219]
    v_lshlrev_b32 v68, 16, v64
    v_and_b32 v69, 0xffff0000, v64
    v_sub_f32 v68, v68, v66
    v_sub_f32 v69, v69, v66
    v_cvt_pk_bf16_f32 v70, v68, v69
    v_lshlrev_b32 v68, 16, v70
    v_and_b32 v69, 0xffff0000, v70
    v_mul_f32 v68, v68, v67
    v_mul_f32 v69, v69, v67
    v_cvt_pk_bf16_f32 v70, v68, v69
    v_lshlrev_b32 v68, 16, v70
    v_and_b32 v69, 0xffff0000, v70
    v_lshlrev_b32 v9, 4, v1
    s_lshl_b32 s54, s35, 10
    v_add_u32 v10, s54, v9
    s_mov_b32 exec_lo, -1
    s_mov_b32 exec_hi, 0
    ds_write_b128 v10, v[212:215] offset:23808
    ds_write_b128 v10, v[216:219] offset:24320
    s_mov_b64 exec, -1
    s_waitcnt lgkmcnt(0)
    v_mov_b32 v11, 8
    v_mov_b32 v12, 1
    s_mov_b64 exec, 1
    ds_add_u32 v11, v12
    s_mov_b64 exec, -1
    v_mov_b32 v11, 8
    s_mov_b32 s96, 0
Lw_31:
    ds_read_b32 v12, v11
    s_waitcnt lgkmcnt(0)
    v_readfirstlane_b32 s54, v12
    s_cmp_ge_u32 s54, 4
    s_cbranch_scc1 Lwd_32
    s_add_u32 s96, s96, 1
    s_cmp_ge_u32 s96, 0x8000
    s_cbranch_scc1 Lwd_32
    s_branch Lw_31
Lwd_32:
    s_lshl_b32 s54, s35, 2
    v_add_u32 v10, s54, v9
    ds_read_b32 v16, v10 offset:23808
    ds_read_b32 v17, v10 offset:24320
    ds_read_b32 v18, v10 offset:24832
    ds_read_b32 v19, v10 offset:25344
    ds_read_b32 v20, v10 offset:25856
    ds_read_b32 v21, v10 offset:26368
    ds_read_b32 v22, v10 offset:26880
    ds_read_b32 v23, v10 offset:27392
    s_waitcnt lgkmcnt(0)
    v_add_f32 v16, v16, v20
    v_add_f32 v18, v18, v22
    v_add_f32 v17, v17, v21
    v_add_f32 v19, v19, v23
    v_cvt_pk_bf16_f32 v24, v16, v17
    v_lshlrev_b32 v16, 16, v24
    v_and_b32 v17, 0xffff0000, v24
    v_cvt_pk_bf16_f32 v24, v18, v19
    v_lshlrev_b32 v18, 16, v24
    v_and_b32 v19, 0xffff0000, v24
    v_add_f32 v18, 1.0, v18
    v_add_f32 v19, 1.0, v19
    v_cvt_pk_bf16_f32 v24, v18, v19
    v_lshlrev_b32 v18, 16, v24
    v_and_b32 v19, 0xffff0000, v24
    v_mul_f32 v68, v68, v18
    v_mul_f32 v69, v69, v19
    v_cvt_pk_bf16_f32 v24, v68, v69
    v_lshlrev_b32 v68, 16, v24
    v_and_b32 v69, 0xffff0000, v24
    v_add_f32 v68, v68, v16
    v_add_f32 v69, v69, v17
    v_cvt_pk_bf16_f32 v68, v68, v69
    s_mul_i32 s59, s32, 1664525
    s_add_u32 s59, s59, 1013904223
    v_mov_b32 v69, s59
    v_lshrrev_b32 v9, 4, v1
    v_mul_u32_u24 v9, 7168, v9
    v_and_b32 v10, 15, v1
    v_lshl_add_u32 v9, v10, 3, v9
    s_mul_i32 s54, s35, 1792
    s_lshl_b32 s55, s15, 7
    s_add_u32 s54, s54, s55
    s_add_u32 s54, s54, 0x2b0000
    s_mov_b32 exec_lo, -1
    s_mov_b32 exec_hi, 0
    buffer_store_dwordx2 v[68:69], v9, s[36:39], s54 offen sc1
    s_mov_b64 exec, -1
L_noA:
    s_and_b32 s54, s2, 3
    s_cmp_lg_u32 s54, 3
    s_cbranch_scc1 L_nob1
    s_mov_b32 s40, s10
    s_mov_b32 s41, s11
    s_mov_b32 s42, 0x380000
    s_mov_b32 s43, 0x00020000
    v_lshrrev_b32 v2, 4, v1
    v_lshlrev_b32 v2, 16, v2
    v_and_b32 v3, 15, v1
    v_lshl_add_u32 v2, v3, 3, v2
    s_lshr_b32 s58, s2, 2
    s_lshl_b32 s56, s58, 7
    s_lshl_b32 s57, s35, 18
    s_add_u32 s56, s56, s57
    s_add_u32 s57, s56, 0
    buffer_load_dwordx2 v[96:97], v2, s[40:43], s57 offen
    s_add_u32 s57, s57, 8192
    buffer_load_dwordx2 v[98:99], v2, s[40:43], s57 offen
    s_add_u32 s57, s57, 8192
    buffer_load_dwordx2 v[100:101], v2, s[40:43], s57 offen
    s_add_u32 s57, s57, 8192
    buffer_load_dwordx2 v[102:103], v2, s[40:43], s57 offen
    s_add_u32 s57, s57, 8192
    buffer_load_dwordx2 v[104:105], v2, s[40:43], s57 offen
    s_add_u32 s57, s57, 8192
    buffer_load_dwordx2 v[106:107], v2, s[40:43], s57 offen
    s_add_u32 s57, s57, 8192
    buffer_load_dwordx2 v[108:109], v2, s[40:43], s57 offen
    s_add_u32 s57, s57, 8192
    buffer_load_dwordx2 v[110:111], v2, s[40:43], s57 offen
    s_add_u32 s57, s57, 8192
    s_add_u32 s57, s56, 1048576
    buffer_load_dwordx2 v[112:113], v2, s[40:43], s57 offen
    s_add_u32 s57, s57, 8192
    buffer_load_dwordx2 v[114:115], v2, s[40:43], s57 offen
    s_add_u32 s57, s57, 8192
    buffer_load_dwordx2 v[116:117], v2, s[40:43], s57 offen
    s_add_u32 s57, s57, 8192
    buffer_load_dwordx2 v[118:119], v2, s[40:43], s57 offen
    s_add_u32 s57, s57, 8192
    buffer_load_dwordx2 v[120:121], v2, s[40:43], s57 offen
    s_add_u32 s57, s57, 8192
    buffer_load_dwordx2 v[122:123], v2, s[40:43], s57 offen
    s_add_u32 s57, s57, 8192
    buffer_load_dwordx2 v[124:125], v2, s[40:43], s57 offen
    s_add_u32 s57, s57, 8192
    buffer_load_dwordx2 v[126:127], v2, s[40:43], s57 offen
    s_add_u32 s57, s57, 8192
    s_add_u32 s57, s56, 2097152
    buffer_load_dwordx2 v[128:129], v2, s[40:43], s57 offen
    s_add_u32 s57, s57, 8192
    buffer_load_dwordx2 v[130:131], v2, s[40:43], s57 offen
    s_add_u32 s57, s57, 8192
    buffer_load_dwordx2 v[132:133], v2, s[40:43], s57 offen
    s_add_u32 s57, s57, 8192
    buffer_load_dwordx2 v[134:135], v2, s[40:43], s57 offen
    s_add_u32 s57, s57, 8192
    buffer_load_dwordx2 v[136:137], v2, s[40:43], s57 offen
    s_add_u32 s57, s57, 8192
    buffer_load_dwordx2 v[138:139], v2, s[40:43], s57 offen
    s_add_u32 s57, s57, 8192
    buffer_load_dwordx2 v[140:141], v2, s[40:43], s57 offen
    s_add_u32 s57, s57, 8192
    buffer_load_dwordx2 v[142:143], v2, s[40:43], s57 offen
    s_add_u32 s57, s57, 8192
    s_add_u32 s57, s56, 3145728
    buffer_load_dwordx2 v[144:145], v2, s[40:43], s57 offen
    s_add_u32 s57, s57, 8192
    buffer_load_dwordx2 v[146:147], v2, s[40:43], s57 offen
    s_add_u32 s57, s57, 8192
    buffer_load_dwordx2 v[148:149], v2, s[40:43], s57 offen
    s_add_u32 s57, s57, 8192
    buffer_load_dwordx2 v[150:151], v2, s[40:43], s57 offen
    s_add_u32 s57, s57, 8192
    buffer_load_dwordx2 v[152:153], v2, s[40:43], s57 offen
    s_add_u32 s57, s57, 8192
    buffer_load_dwordx2 v[154:155], v2, s[40:43], s57 offen
    s_add_u32 s57, s57, 8192
    buffer_load_dwordx2 v[156:157], v2, s[40:43], s57 offen
    s_add_u32 s57, s57, 8192
    buffer_load_dwordx2 v[158:159], v2, s[40:43], s57 offen
    s_add_u32 s57, s57, 8192
L_nob1:
    s_waitcnt lgkmcnt(0)
    s_mul_i32 s32, s32, 1664525
    s_add_u32 s32, s32, 1013904223
    s_cmp_lg_u32 s35, 0
    s_cbranch_scc1 L_nocnt
    s_mov_b32 s44, s28
    s_mov_b32 s45, s29
    s_mov_b32 s46, 0x100
    s_mov_b32 s47, 0x00020000
    v_mov_b32 v8, 0
    v_mov_b32 v9, 1
    s_mov_b64 exec, 1
    buffer_atomic_add v9, v8, s[44:47], 0 offen sc1
    s_mov_b64 exec, -1
    s_bitcmp1_b32 s14, 0
    s_cbranch_scc1 L_nocnt
    v_mov_b32 v10, 0
    v_mov_b32 v11, s32
    s_lshr_b32 s54, s14, 1
    s_lshl_b32 s54, s54, 7
    s_add_u32 s54, s54, 0x2e0000
    s_mov_b64 exec, 1
    buffer_store_dwordx2 v[10:11], v8, s[36:39], s54 offen sc1
    s_mov_b64 exec, -1
L_nocnt:
    s_and_b32 s54, s2, 3
    s_cmp_lg_u32 s54, 3
    s_cbranch_scc1 L_nob2
    v_and_b32 v3, 7, v1
    v_mul_u32_u24 v3, 1792, v3
    v_lshrrev_b32 v4, 4, v1
    v_lshl_add_u32 v3, v4, 5, v3
    s_lshl_b32 s55, s35, 7
    s_add_u32 s55, s55, 0x2b0000
    s_add_u32 s56, s55, 1536
    s_add_u32 s57, s55, 1024
    s_cmp_ge_u32 s35, 2
    s_cselect_b32 s56, s57, s56
    v_bfe_u32 v4, v1, 3, 1
    v_lshl_add_u32 v3, v4, 4, v3
    s_waitcnt vmcnt(0)
    s_mov_b32 s96, 0
Lp_33:
    buffer_load_dwordx4 v[32:35], v3, s[36:39], s55 offen offset:0 sc1
    buffer_load_dwordx4 v[36:39], v3, s[36:39], s55 offen offset:512 sc1
    buffer_load_dwordx4 v[40:43], v3, s[36:39], s55 offen offset:1024 sc1
    buffer_load_dwordx4 v[44:47], v3, s[36:39], s56 offen offset:0 sc1
    s_waitcnt vmcnt(0)
    v_xor_b32 v33, s32, v33
    v_xor_b32 v35, s32, v35
    v_or_b32 v33, v33, v35
    v_xor_b32 v37, s32, v37
    v_or_b32 v33, v33, v37
    v_xor_b32 v39, s32, v39
    v_or_b32 v33, v33, v39
    v_xor_b32 v41, s32, v41
    v_or_b32 v33, v33, v41
    v_xor_b32 v43, s32, v43
    v_or_b32 v33, v33, v43
    v_xor_b32 v45, s32, v45
    v_or_b32 v33, v33, v45
    v_xor_b32 v47, s32, v47
    v_or_b32 v33, v33, v47
    v_cmp_ne_u32 vcc, 0, v33
    s_cmp_eq_u64 vcc, 0
    s_cbranch_scc1 Lpd_34
    s_add_u32 s96, s96, 1
    s_cmp_ge_u32 s96, 0x8000
    s_cbranch_scc1 Lpd_34
    s_sleep 4
    s_branch Lp_33
Lpd_34:
    v_perm_b32 v160, v98, v96, s62
    v_perm_b32 v161, v102, v100, s62
    v_perm_b32 v162, v106, v104, s62
    v_perm_b32 v163, v110, v108, s62
    v_perm_b32 v164, v98, v96, s63
    v_perm_b32 v165, v102, v100, s63
    v_perm_b32 v166, v106, v104, s63
    v_perm_b32 v167, v110, v108, s63
    v_perm_b32 v168, v99, v97, s62
    v_perm_b32 v169, v103, v101, s62
    v_perm_b32 v170, v107, v105, s62
    v_perm_b32 v171, v111, v109, s62
    v_perm_b32 v172, v99, v97, s63
    v_perm_b32 v173, v103, v101, s63
    v_perm_b32 v174, v107, v105, s63
    v_perm_b32 v175, v111, v109, s63
    v_perm_b32 v176, v114, v112, s62
    v_perm_b32 v177, v118, v116, s62
    v_perm_b32 v178, v122, v120, s62
    v_perm_b32 v179, v126, v124, s62
    v_perm_b32 v180, v114, v112, s63
    v_perm_b32 v181, v118, v116, s63
    v_perm_b32 v182, v122, v120, s63
    v_perm_b32 v183, v126, v124, s63
    v_perm_b32 v184, v115, v113, s62
    v_perm_b32 v185, v119, v117, s62
    v_perm_b32 v186, v123, v121, s62
    v_perm_b32 v187, v127, v125, s62
    v_perm_b32 v188, v115, v113, s63
    v_perm_b32 v189, v119, v117, s63
    v_perm_b32 v190, v123, v121, s63
    v_perm_b32 v191, v127, v125, s63
    v_perm_b32 v192, v130, v128, s62
    v_perm_b32 v193, v134, v132, s62
    v_perm_b32 v194, v138, v136, s62
    v_perm_b32 v195, v142, v140, s62
    v_perm_b32 v196, v130, v128, s63
    v_perm_b32 v197, v134, v132, s63
    v_perm_b32 v198, v138, v136, s63
    v_perm_b32 v199, v142, v140, s63
    v_perm_b32 v200, v131, v129, s62
    v_perm_b32 v201, v135, v133, s62
    v_perm_b32 v202, v139, v137, s62
    v_perm_b32 v203, v143, v141, s62
    v_perm_b32 v204, v131, v129, s63
    v_perm_b32 v205, v135, v133, s63
    v_perm_b32 v206, v139, v137, s63
    v_perm_b32 v207, v143, v141, s63
    v_perm_b32 v208, v146, v144, s62
    v_perm_b32 v209, v150, v148, s62
    v_perm_b32 v210, v154, v152, s62
    v_perm_b32 v211, v158, v156, s62
    v_perm_b32 v212, v146, v144, s63
    v_perm_b32 v213, v150, v148, s63
    v_perm_b32 v214, v154, v152, s63
    v_perm_b32 v215, v158, v156, s63
    v_perm_b32 v216, v147, v145, s62
    v_perm_b32 v217, v151, v149, s62
    v_perm_b32 v218, v155, v153, s62
    v_perm_b32 v219, v159, v157, s62
    v_perm_b32 v220, v147, v145, s63
    v_perm_b32 v221, v151, v149, s63
    v_perm_b32 v222, v155, v153, s63
    v_perm_b32 v223, v159, v157, s63
    v_mov_b32 v64, v32
    v_mov_b32 v65, v34
    v_mov_b32_dpp v66, v32 row_ror:8 row_mask:0xf bank_mask:0xf
    v_mov_b32_dpp v67, v34 row_ror:8 row_mask:0xf bank_mask:0xf
    v_mov_b32 v68, v36
    v_mov_b32 v69, v38
    v_mov_b32_dpp v70, v36 row_ror:8 row_mask:0xf bank_mask:0xf
    v_mov_b32_dpp v71, v38 row_ror:8 row_mask:0xf bank_mask:0xf
    v_mov_b32 v72, v40
    v_mov_b32 v73, v42
    v_mov_b32_dpp v74, v40 row_ror:8 row_mask:0xf bank_mask:0xf
    v_mov_b32_dpp v75, v42 row_ror:8 row_mask:0xf bank_mask:0xf
    v_mov_b32 v76, v44
    v_mov_b32 v77, v46
    v_mov_b32_dpp v78, v44 row_ror:8 row_mask:0xf bank_mask:0xf
    v_mov_b32_dpp v79, v46 row_ror:8 row_mask:0xf bank_mask:0xf
    v_mfma_f32_16x16x32_bf16 v[80:83], v[64:67], v[160:163], 0
    v_mfma_f32_16x16x32_bf16 v[84:87], v[64:67], v[164:167], 0
    v_mfma_f32_16x16x32_bf16 v[88:91], v[64:67], v[168:171], 0
    v_mfma_f32_16x16x32_bf16 v[92:95], v[64:67], v[172:175], 0
    v_mfma_f32_16x16x32_bf16 v[80:83], v[68:71], v[176:179], v[80:83]
    v_mfma_f32_16x16x32_bf16 v[84:87], v[68:71], v[180:183], v[84:87]
    v_mfma_f32_16x16x32_bf16 v[88:91], v[68:71], v[184:187], v[88:91]
    v_mfma_f32_16x16x32_bf16 v[92:95], v[68:71], v[188:191], v[92:95]
    v_mfma_f32_16x16x32_bf16 v[80:83], v[72:75], v[192:195], v[80:83]
    v_mfma_f32_16x16x32_bf16 v[84:87], v[72:75], v[196:199], v[84:87]
    v_mfma_f32_16x16x32_bf16 v[88:91], v[72:75], v[200:203], v[88:91]
    v_mfma_f32_16x16x32_bf16 v[92:95], v[72:75], v[204:207], v[92:95]
    s_cmp_ge_u32 s35, 2
    s_cbranch_scc1 L_B3
    v_mfma_f32_16x16x32_bf16 v[80:83], v[76:79], v[208:211], v[80:83]
    v_mfma_f32_16x16x32_bf16 v[84:87], v[76:79], v[212:215], v[84:87]
    v_mfma_f32_16x16x32_bf16 v[88:91], v[76:79], v[216:219], v[88:91]
    v_mfma_f32_16x16x32_bf16 v[92:95], v[76:79], v[220:223], v[92:95]
L_B3:
    s_nop 7
    v_lshlrev_b32 v9, 4, v1
    s_lshl_b32 s54, s35, 11
    v_add_u32 v10, s54, v9
    s_mov_b32 exec_lo, -1
    s_mov_b32 exec_hi, 0
    ds_write_b128 v10, v[80:83] offset:23808
    ds_write_b128 v10, v[84:87] offset:24320
    ds_write_b128 v10, v[88:91] offset:24832
    ds_write_b128 v10, v[92:95] offset:25344
    s_mov_b64 exec, -1
    s_waitcnt lgkmcnt(0)
    v_mov_b32 v11, 12
    v_mov_b32 v12, 1
    s_mov_b64 exec, 1
    ds_add_u32 v11, v12
    s_mov_b64 exec, -1
    v_lshrrev_b32 v13, 4, v1
    v_lshlrev_b32 v13, 16, v13
    v_and_b32 v14, 15, v1
    v_lshl_add_u32 v13, v14, 4, v13
    s_lshl_b32 s55, s35, 14
    s_lshl_b32 s56, s58, 8
    s_add_u32 s55, s55, s56
    s_add_u32 s55, s55, 0x2c0000
    v_mov_b32 v11, 12
    s_mov_b32 s96, 0
Lw_35:
    ds_read_b32 v12, v11
    s_waitcnt lgkmcnt(0)
    v_readfirstlane_b32 s54, v12
    s_cmp_ge_u32 s54, 4
    s_cbranch_scc1 Lwd_36
    s_add_u32 s96, s96, 1
    s_cmp_ge_u32 s96, 0x8000
    s_cbranch_scc1 Lwd_36
    s_branch Lw_35
Lwd_36:
    s_lshl_b32 s54, s35, 2
    v_add_u32 v10, s54, v9
    ds_read_b32 v32, v10 offset:23808
    ds_read_b32 v33, v10 offset:25856
    ds_read_b32 v34, v10 offset:27904
    ds_read_b32 v35, v10 offset:29952
    ds_read_b32 v36, v10 offset:24320
    ds_read_b32 v37, v10 offset:26368
    ds_read_b32 v38, v10 offset:28416
    ds_read_b32 v39, v10 offset:30464
    ds_read_b32 v40, v10 offset:24832
    ds_read_b32 v41, v10 offset:26880
    ds_read_b32 v42, v10 offset:28928
    ds_read_b32 v43, v10 offset:30976
    ds_read_b32 v44, v10 offset:25344
    ds_read_b32 v45, v10 offset:27392
    ds_read_b32 v46, v10 offset:29440
    ds_read_b32 v47, v10 offset:31488
    s_waitcnt lgkmcnt(0)
    v_add_f32 v32, v32, v33
    v_add_f32 v34, v34, v35
    v_add_f32 v36, v36, v37
    v_add_f32 v38, v38, v39
    v_add_f32 v40, v40, v41
    v_add_f32 v42, v42, v43
    v_add_f32 v44, v44, v45
    v_add_f32 v46, v46, v47
    v_add_f32 v32, v32, v34
    v_add_f32 v36, v36, v38
    v_add_f32 v40, v40, v42
    v_add_f32 v44, v44, v46
    v_cvt_pk_bf16_f32 v48, v32, v36
    v_cvt_pk_bf16_f32 v50, v40, v44
    v_mov_b32 v49, s32
    v_mov_b32 v51, s32
    s_mov_b32 exec_lo, -1
    s_mov_b32 exec_hi, 0
    buffer_store_dwordx4 v[48:51], v13, s[36:39], s55 offen sc1
    s_mov_b64 exec, -1
L_nob2:
    s_cmp_lg_u32 s35, 0
    s_cbranch_scc1 L_noq
    s_lshl_b32 s54, s33, 14
    s_lshl_b32 s55, s34, 10
    s_add_u32 s54, s54, s55
    s_add_u32 s54, s54, 0x2c0000
    v_lshlrev_b32 v9, 4, v1
    s_mov_b32 s96, 0
Lp_37:
    buffer_load_dwordx4 v[32:35], v9, s[36:39], s54 offen sc1
    s_waitcnt vmcnt(0)
    v_xor_b32 v33, s32, v33
    v_xor_b32 v35, s32, v35
    v_or_b32 v33, v33, v35
    v_cmp_ne_u32 vcc, 0, v33
    s_cmp_eq_u64 vcc, 0
    s_cbranch_scc1 Lpd_38
    s_add_u32 s96, s96, 1
    s_cmp_ge_u32 s96, 0x8000
    s_cbranch_scc1 Lpd_38
    s_sleep 4
    s_branch Lp_37
Lpd_38:
    v_mov_b32 v33, v34
    v_lshlrev_b32 v9, 3, v1
    ds_write_b64 v9, v[32:33] offset:128
    s_waitcnt lgkmcnt(0)
    v_mov_b32 v10, 0
    v_mov_b32 v11, 1
    s_mov_b64 exec, 1
    ds_add_u32 v10, v11
    s_mov_b64 exec, -1
L_noq:
    s_cmp_lt_u32 s15, 14
    s_cbranch_scc1 L_noA2
    s_cmp_ge_u32 s15, 42
    s_cbranch_scc1 L_noA2
    s_mov_b32 s44, s22
    s_mov_b32 s45, s23
    s_mov_b32 s46, 0x1c00
    s_mov_b32 s47, 0x00020000
    s_lshl_b32 s54, s35, 10
    v_lshlrev_b32 v8, 4, v1
    v_add_u32 v8, s54, v8
    buffer_load_dwordx4 v[16:19], v8, s[44:47], 0 offen
    s_mov_b32 s55, 4096
    buffer_load_dwordx4 v[20:23], v8, s[44:47], s55 offen
    s_mov_b32 s40, s24
    s_mov_b32 s41, s25
    s_mov_b32 s42, 0x24c000
    s_mov_b32 s43, 0x00020000
    v_lshrrev_b32 v2, 4, v1
    v_mul_u32_u24 v2, 43008, v2
    v_and_b32 v3, 15, v1
    v_lshl_add_u32 v2, v3, 3, v2
    s_lshl_b32 s56, s15, 7
    s_mul_i32 s57, s35, 172032
    s_add_u32 s56, s56, s57
    s_add_u32 s57, s56, 0
    buffer_load_dwordx2 v[64:65], v2, s[40:43], s57 offen
    s_add_u32 s57, s57, 5376
    buffer_load_dwordx2 v[66:67], v2, s[40:43], s57 offen
    s_add_u32 s57, s57, 5376
    buffer_load_dwordx2 v[68:69], v2, s[40:43], s57 offen
    s_add_u32 s57, s57, 5376
    buffer_load_dwordx2 v[70:71], v2, s[40:43], s57 offen
    s_add_u32 s57, s57, 5376
    buffer_load_dwordx2 v[72:73], v2, s[40:43], s57 offen
    s_add_u32 s57, s57, 5376
    buffer_load_dwordx2 v[74:75], v2, s[40:43], s57 offen
    s_add_u32 s57, s57, 5376
    buffer_load_dwordx2 v[76:77], v2, s[40:43], s57 offen
    s_add_u32 s57, s57, 5376
    buffer_load_dwordx2 v[78:79], v2, s[40:43], s57 offen
    s_add_u32 s57, s57, 5376
    s_add_u32 s57, s56, 688128
    buffer_load_dwordx2 v[80:81], v2, s[40:43], s57 offen
    s_add_u32 s57, s57, 5376
    buffer_load_dwordx2 v[82:83], v2, s[40:43], s57 offen
    s_add_u32 s57, s57, 5376
    buffer_load_dwordx2 v[84:85], v2, s[40:43], s57 offen
    s_add_u32 s57, s57, 5376
    buffer_load_dwordx2 v[86:87], v2, s[40:43], s57 offen
    s_add_u32 s57, s57, 5376
    buffer_load_dwordx2 v[88:89], v2, s[40:43], s57 offen
    s_add_u32 s57, s57, 5376
    buffer_load_dwordx2 v[90:91], v2, s[40:43], s57 offen
    s_add_u32 s57, s57, 5376
    buffer_load_dwordx2 v[92:93], v2, s[40:43], s57 offen
    s_add_u32 s57, s57, 5376
    buffer_load_dwordx2 v[94:95], v2, s[40:43], s57 offen
    s_add_u32 s57, s57, 5376
    s_add_u32 s57, s56, 1376256
    buffer_load_dwordx2 v[96:97], v2, s[40:43], s57 offen
    s_add_u32 s57, s57, 5376
    buffer_load_dwordx2 v[98:99], v2, s[40:43], s57 offen
    s_add_u32 s57, s57, 5376
    buffer_load_dwordx2 v[100:101], v2, s[40:43], s57 offen
    s_add_u32 s57, s57, 5376
    buffer_load_dwordx2 v[102:103], v2, s[40:43], s57 offen
    s_add_u32 s57, s57, 5376
    buffer_load_dwordx2 v[104:105], v2, s[40:43], s57 offen
    s_add_u32 s57, s57, 5376
    buffer_load_dwordx2 v[106:107], v2, s[40:43], s57 offen
    s_add_u32 s57, s57, 5376
    buffer_load_dwordx2 v[108:109], v2, s[40:43], s57 offen
    s_add_u32 s57, s57, 5376
    buffer_load_dwordx2 v[110:111], v2, s[40:43], s57 offen
    s_add_u32 s57, s57, 5376
    s_add_u32 s57, s56, 2064384
    buffer_load_dwordx2 v[112:113], v2, s[40:43], s57 offen
    s_add_u32 s57, s57, 5376
    buffer_load_dwordx2 v[114:115], v2, s[40:43], s57 offen
    s_add_u32 s57, s57, 5376
    buffer_load_dwordx2 v[116:117], v2, s[40:43], s57 offen
    s_add_u32 s57, s57, 5376
    buffer_load_dwordx2 v[118:119], v2, s[40:43], s57 offen
    s_add_u32 s57, s57, 5376
    buffer_load_dwordx2 v[120:121], v2, s[40:43], s57 offen
    s_add_u32 s57, s57, 5376
    buffer_load_dwordx2 v[122:123], v2, s[40:43], s57 offen
    s_add_u32 s57, s57, 5376
    buffer_load_dwordx2 v[124:125], v2, s[40:43], s57 offen
    s_add_u32 s57, s57, 5376
    buffer_load_dwordx2 v[126:127], v2, s[40:43], s57 offen
    s_add_u32 s57, s57, 5376
    s_waitcnt vmcnt(32)
    v_lshlrev_b32 v24, 16, v16
    v_and_b32 v25, 0xffff0000, v16
    v_lshlrev_b32 v26, 16, v17
    v_and_b32 v27, 0xffff0000, v17
    v_lshlrev_b32 v28, 16, v18
    v_and_b32 v29, 0xffff0000, v18
    v_lshlrev_b32 v30, 16, v19
    v_and_b32 v31, 0xffff0000, v19
    v_lshlrev_b32 v32, 16, v20
    v_and_b32 v33, 0xffff0000, v20
    v_lshlrev_b32 v34, 16, v21
    v_and_b32 v35, 0xffff0000, v21
    v_lshlrev_b32 v36, 16, v22
    v_and_b32 v37, 0xffff0000, v22
    v_lshlrev_b32 v38, 16, v23
    v_and_b32 v39, 0xffff0000, v23
    v_mul_f32 v40, 0xbfb8aa3b, v24
    v_mul_f32 v41, 0xbfb8aa3b, v25
    v_mul_f32 v42, 0xbfb8aa3b, v26
    v_mul_f32 v43, 0xbfb8aa3b, v27
    v_mul_f32 v44, 0xbfb8aa3b, v28
    v_mul_f32 v45, 0xbfb8aa3b, v29
    v_mul_f32 v46, 0xbfb8aa3b, v30
    v_mul_f32 v47, 0xbfb8aa3b, v31
    v_mul_f32 v48, 0xbfb8aa3b, v32
    v_mul_f32 v49, 0xbfb8aa3b, v33
    v_mul_f32 v50, 0xbfb8aa3b, v34
    v_mul_f32 v51, 0xbfb8aa3b, v35
    v_mul_f32 v52, 0xbfb8aa3b, v36
    v_mul_f32 v53, 0xbfb8aa3b, v37
    v_mul_f32 v54, 0xbfb8aa3b, v38
    v_mul_f32 v55, 0xbfb8aa3b, v39
    v_exp_f32 v40, v40
    v_exp_f32 v41, v41
    v_exp_f32 v42, v42
    v_exp_f32 v43, v43
    v_exp_f32 v44, v44
    v_exp_f32 v45, v45
    v_exp_f32 v46, v46
    v_exp_f32 v47, v47
    v_exp_f32 v48, v48
    v_exp_f32 v49, v49
    v_exp_f32 v50, v50
    v_exp_f32 v51, v51
    v_exp_f32 v52, v52
    v_exp_f32 v53, v53
    v_exp_f32 v54, v54
    v_exp_f32 v55, v55
    v_add_f32 v40, 1.0, v40
    v_add_f32 v41, 1.0, v41
    v_add_f32 v42, 1.0, v42
    v_add_f32 v43, 1.0, v43
    v_add_f32 v44, 1.0, v44
    v_add_f32 v45, 1.0, v45
    v_add_f32 v46, 1.0, v46
    v_add_f32 v47, 1.0, v47
    v_add_f32 v48, 1.0, v48
    v_add_f32 v49, 1.0, v49
    v_add_f32 v50, 1.0, v50
    v_add_f32 v51, 1.0, v51
    v_add_f32 v52, 1.0, v52
    v_add_f32 v53, 1.0, v53
    v_add_f32 v54, 1.0, v54
    v_add_f32 v55, 1.0, v55
    v_rcp_f32 v40, v40
    v_rcp_f32 v41, v41
    v_rcp_f32 v42, v42
    v_rcp_f32 v43, v43
    v_rcp_f32 v44, v44
    v_rcp_f32 v45, v45
    v_rcp_f32 v46, v46
    v_rcp_f32 v47, v47
    v_rcp_f32 v48, v48
    v_rcp_f32 v49, v49
    v_rcp_f32 v50, v50
    v_rcp_f32 v51, v51
    v_rcp_f32 v52, v52
    v_rcp_f32 v53, v53
    v_rcp_f32 v54, v54
    v_rcp_f32 v55, v55
    v_mul_f32 v24, v24, v40
    v_mul_f32 v25, v25, v41
    v_mul_f32 v26, v26, v42
    v_mul_f32 v27, v27, v43
    v_mul_f32 v28, v28, v44
    v_mul_f32 v29, v29, v45
    v_mul_f32 v30, v30, v46
    v_mul_f32 v31, v31, v47
    v_mul_f32 v32, v32, v48
    v_mul_f32 v33, v33, v49
    v_mul_f32 v34, v34, v50
    v_mul_f32 v35, v35, v51
    v_mul_f32 v36, v36, v52
    v_mul_f32 v37, v37, v53
    v_mul_f32 v38, v38, v54
    v_mul_f32 v39, v39, v55
    v_cvt_pk_bf16_f32 v16, v24, v25
    v_cvt_pk_bf16_f32 v17, v26, v27
    v_cvt_pk_bf16_f32 v18, v28, v29
    v_cvt_pk_bf16_f32 v19, v30, v31
    v_cvt_pk_bf16_f32 v20, v32, v33
    v_cvt_pk_bf16_f32 v21, v34, v35
    v_cvt_pk_bf16_f32 v22, v36, v37
    v_cvt_pk_bf16_f32 v23, v38, v39
    ds_write_b128 v8, v[16:19] offset:16640
    s_cmp_eq_u32 s35, 3
    s_cbranch_scc1 L_si_39
    ds_write_b128 v8, v[20:23] offset:20736
L_si_39:
    s_waitcnt lgkmcnt(0)
    v_mov_b32 v9, 4
    v_mov_b32 v10, 1
    s_mov_b64 exec, 1
    ds_add_u32 v9, v10
    s_mov_b64 exec, -1
    v_mov_b32 v9, 4
    s_mov_b32 s96, 0
Lw_40:
    ds_read_b32 v10, v9
    s_waitcnt lgkmcnt(0)
    v_readfirstlane_b32 s54, v10
    s_cmp_ge_u32 s54, 4
    s_cbranch_scc1 Lwd_41
    s_add_u32 s96, s96, 1
    s_cmp_ge_u32 s96, 0x8000
    s_cbranch_scc1 Lwd_41
    s_branch Lw_40
Lwd_41:
    v_and_b32 v9, 7, v1
    v_mul_u32_u24 v9, 896, v9
    v_lshrrev_b32 v10, 4, v1
    v_lshl_add_u32 v9, v10, 4, v9
    s_lshl_b32 s54, s35, 6
    v_add_u32 v9, s54, v9
    ds_read_b128 v[192:195], v9 offset:16640
    ds_read_b128 v[196:199], v9 offset:16896
    ds_read_b128 v[200:203], v9 offset:17152
    s_cmp_ge_u32 s35, 2
    s_cbranch_scc1 L_A2
    ds_read_b128 v[204:207], v9 offset:17408
L_A2:
    s_waitcnt vmcnt(24)
    v_perm_b32 v128, v66, v64, s62
    v_perm_b32 v129, v70, v68, s62
    v_perm_b32 v130, v74, v72, s62
    v_perm_b32 v131, v78, v76, s62
    v_perm_b32 v132, v66, v64, s63
    v_perm_b32 v133, v70, v68, s63
    v_perm_b32 v134, v74, v72, s63
    v_perm_b32 v135, v78, v76, s63
    v_perm_b32 v136, v67, v65, s62
    v_perm_b32 v137, v71, v69, s62
    v_perm_b32 v138, v75, v73, s62
    v_perm_b32 v139, v79, v77, s62
    v_perm_b32 v140, v67, v65, s63
    v_perm_b32 v141, v71, v69, s63
    v_perm_b32 v142, v75, v73, s63
    v_perm_b32 v143, v79, v77, s63
    s_waitcnt vmcnt(16)
    v_perm_b32 v144, v82, v80, s62
    v_perm_b32 v145, v86, v84, s62
    v_perm_b32 v146, v90, v88, s62
    v_perm_b32 v147, v94, v92, s62
    v_perm_b32 v148, v82, v80, s63
    v_perm_b32 v149, v86, v84, s63
    v_perm_b32 v150, v90, v88, s63
    v_perm_b32 v151, v94, v92, s63
    v_perm_b32 v152, v83, v81, s62
    v_perm_b32 v153, v87, v85, s62
    v_perm_b32 v154, v91, v89, s62
    v_perm_b32 v155, v95, v93, s62
    v_perm_b32 v156, v83, v81, s63
    v_perm_b32 v157, v87, v85, s63
    v_perm_b32 v158, v91, v89, s63
    v_perm_b32 v159, v95, v93, s63
    s_waitcnt vmcnt(8)
    v_perm_b32 v160, v98, v96, s62
    v_perm_b32 v161, v102, v100, s62
    v_perm_b32 v162, v106, v104, s62
    v_perm_b32 v163, v110, v108, s62
    v_perm_b32 v164, v98, v96, s63
    v_perm_b32 v165, v102, v100, s63
    v_perm_b32 v166, v106, v104, s63
    v_perm_b32 v167, v110, v108, s63
    v_perm_b32 v168, v99, v97, s62
    v_perm_b32 v169, v103, v101, s62
    v_perm_b32 v170, v107, v105, s62
    v_perm_b32 v171, v111, v109, s62
    v_perm_b32 v172, v99, v97, s63
    v_perm_b32 v173, v103, v101, s63
    v_perm_b32 v174, v107, v105, s63
    v_perm_b32 v175, v111, v109, s63
    s_waitcnt vmcnt(0)
    v_perm_b32 v176, v114, v112, s62
    v_perm_b32 v177, v118, v116, s62
    v_perm_b32 v178, v122, v120, s62
    v_perm_b32 v179, v126, v124, s62
    v_perm_b32 v180, v114, v112, s63
    v_perm_b32 v181, v118, v116, s63
    v_perm_b32 v182, v122, v120, s63
    v_perm_b32 v183, v126, v124, s63
    v_perm_b32 v184, v115, v113, s62
    v_perm_b32 v185, v119, v117, s62
    v_perm_b32 v186, v123, v121, s62
    v_perm_b32 v187, v127, v125, s62
    v_perm_b32 v188, v115, v113, s63
    v_perm_b32 v189, v119, v117, s63
    v_perm_b32 v190, v123, v121, s63
    v_perm_b32 v191, v127, v125, s63
    s_waitcnt lgkmcnt(0)
    v_mfma_f32_16x16x32_bf16 v[208:211], v[192:195], v[128:131], 0
    v_mfma_f32_16x16x32_bf16 v[212:215], v[192:195], v[132:135], 0
    v_mfma_f32_16x16x32_bf16 v[216:219], v[192:195], v[136:139], 0
    v_mfma_f32_16x16x32_bf16 v[220:223], v[192:195], v[140:143], 0
    v_mfma_f32_16x16x32_bf16 v[208:211], v[196:199], v[144:147], v[208:211]
    v_mfma_f32_16x16x32_bf16 v[212:215], v[196:199], v[148:151], v[212:215]
    v_mfma_f32_16x16x32_bf16 v[216:219], v[196:199], v[152:155], v[216:219]
    v_mfma_f32_16x16x32_bf16 v[220:223], v[196:199], v[156:159], v[220:223]
    v_mfma_f32_16x16x32_bf16 v[208:211], v[200:203], v[160:163], v[208:211]
    v_mfma_f32_16x16x32_bf16 v[212:215], v[200:203], v[164:167], v[212:215]
    v_mfma_f32_16x16x32_bf16 v[216:219], v[200:203], v[168:171], v[216:219]
    v_mfma_f32_16x16x32_bf16 v[220:223], v[200:203], v[172:175], v[220:223]
    s_cmp_ge_u32 s35, 2
    s_cbranch_scc1 L_A3
    v_mfma_f32_16x16x32_bf16 v[208:211], v[204:207], v[176:179], v[208:211]
    v_mfma_f32_16x16x32_bf16 v[212:215], v[204:207], v[180:183], v[212:215]
    v_mfma_f32_16x16x32_bf16 v[216:219], v[204:207], v[184:187], v[216:219]
    v_mfma_f32_16x16x32_bf16 v[220:223], v[204:207], v[188:191], v[220:223]
L_A3:
    s_nop 7
    v_lshlrev_b32 v9, 4, v1
    s_lshl_b32 s54, s35, 11
    v_add_u32 v10, s54, v9
    s_mov_b32 exec_lo, -1
    s_mov_b32 exec_hi, 0
    ds_write_b128 v10, v[208:211] offset:23808
    ds_write_b128 v10, v[212:215] offset:24320
    ds_write_b128 v10, v[216:219] offset:24832
    ds_write_b128 v10, v[220:223] offset:25344
    s_mov_b64 exec, -1
    s_waitcnt lgkmcnt(0)
    v_mov_b32 v11, 8
    v_mov_b32 v12, 1
    s_mov_b64 exec, 1
    ds_add_u32 v11, v12
    s_mov_b64 exec, -1
    v_mov_b32 v11, 8
    s_mov_b32 s96, 0
Lw_42:
    ds_read_b32 v12, v11
    s_waitcnt lgkmcnt(0)
    v_readfirstlane_b32 s54, v12
    s_cmp_ge_u32 s54, 4
    s_cbranch_scc1 Lwd_43
    s_add_u32 s96, s96, 1
    s_cmp_ge_u32 s96, 0x8000
    s_cbranch_scc1 Lwd_43
    s_branch Lw_42
Lwd_43:
    s_lshl_b32 s54, s35, 9
    v_add_u32 v10, s54, v9
    s_mov_b32 exec_lo, -1
    s_mov_b32 exec_hi, 0
    ds_read_b128 v[16:19], v10 offset:23808
    ds_read_b128 v[20:23], v10 offset:25856
    ds_read_b128 v[24:27], v10 offset:27904
    ds_read_b128 v[28:31], v10 offset:29952
    s_waitcnt lgkmcnt(0)
    v_add_f32 v16, v16, v20
    v_add_f32 v24, v24, v28
    v_add_f32 v17, v17, v21
    v_add_f32 v25, v25, v29
    v_add_f32 v18, v18, v22
    v_add_f32 v26, v26, v30
    v_add_f32 v19, v19, v23
    v_add_f32 v27, v27, v31
    v_add_f32 v16, v16, v24
    v_add_f32 v17, v17, v25
    v_add_f32 v18, v18, v26
    v_add_f32 v19, v19, v27
    v_cvt_pk_bf16_f32 v20, v16, v17
    v_lshlrev_b32 v16, 16, v20
    v_and_b32 v17, 0xffff0000, v20
    v_cvt_pk_bf16_f32 v21, v18, v19
    v_lshlrev_b32 v18, 16, v21
    v_and_b32 v19, 0xffff0000, v21
    s_mov_b32 s59, s32
    v_lshrrev_b32 v9, 4, v1
    v_mul_u32_u24 v9, 86016, v9
    v_and_b32 v10, 15, v1
    v_lshl_add_u32 v9, v10, 3, v9
    s_lshl_b32 s54, s15, 2
    s_add_u32 s54, s54, s35
    s_lshl_b32 s54, s54, 7
    s_add_u32 s54, s54, 0x1000
    v_mov_b32 v24, v16
    v_mov_b32 v25, s59
    v_mov_b32 v26, v17
    v_mov_b32 v27, s59
    v_mov_b32 v28, v18
    v_mov_b32 v29, s59
    v_mov_b32 v30, v19
    v_mov_b32 v31, s59
    buffer_store_dwordx2 v[24:25], v9, s[36:39], s54 offen sc1
    s_add_u32 s54, s54, 21504
    buffer_store_dwordx2 v[26:27], v9, s[36:39], s54 offen sc1
    s_add_u32 s54, s54, 21504
    buffer_store_dwordx2 v[28:29], v9, s[36:39], s54 offen sc1
    s_add_u32 s54, s54, 21504
    buffer_store_dwordx2 v[30:31], v9, s[36:39], s54 offen sc1
    s_add_u32 s54, s54, 21504
    s_mov_b64 exec, -1
L_noA2:
    s_setprio 3
    s_and_b32 s58, s2, 63
    s_lshr_b32 s54, s58, 3
    s_and_b32 s55, s58, 7
    s_lshr_b32 s56, s54, 1
    s_lshl_b32 s56, s56, 4
    s_lshl_b32 s57, s55, 1
    s_add_u32 s56, s56, s57
    s_and_b32 s57, s54, 1
    s_add_u32 s56, s56, s57
    s_add_u32 s57, s55, 48
    s_cmp_eq_u32 s54, 6
    s_cselect_b32 s58, s57, s56
    v_lshrrev_b32 v2, 4, v1
    v_mul_u32_u24 v2, 7168, v2
    v_and_b32 v3, 15, v1
    v_lshl_add_u32 v2, v3, 3, v2
    v_lshrrev_b32 v8, 4, v1
    v_mul_u32_u24 v8, 28672, v8
    v_lshl_add_u32 v8, v3, 2, v8
    s_mov_b32 s40, s12
    s_mov_b32 s41, s13
    s_mov_b32 s42, 0x380000
    s_mov_b32 s43, 0x00020000
    s_mov_b32 s48, s20
    s_mov_b32 s49, s21
    s_mov_b32 s50, 0x188000
    s_mov_b32 s51, 0x00020000
    s_and_b32 s54, s35, 1
    s_cmp_eq_u32 s54, 0
    s_cselect_b32 s44, s16, s18
    s_cselect_b32 s45, s17, s19
    s_mov_b32 s46, 0x188000
    s_mov_b32 s47, 0x00020000
    s_mul_i32 s98, s58, 28672
    s_lshl_b32 s55, s35, 7
    s_add_u32 s98, s98, s55
    s_lshr_b32 s99, s35, 1
    s_mul_i32 s99, s99, 802816
    s_lshl_b32 s55, s58, 6
    s_add_u32 s99, s99, s55
    s_mul_i32 s101, s34, 229376
    s_lshl_b32 s55, s35, 7
    s_add_u32 s101, s101, s55
    s_add_u32 s100, s101, 512
    s_cmp_eq_u32 s35, 3
    s_cselect_b32 s100, 0x7f000000, s100
    v_lshlrev_b32 v9, 4, v1
    s_lshl_b32 s55, s35, 12
    s_add_u32 s55, s55, 32768
    v_add_u32 v10, s55, v9
    s_lshl_b32 s55, s35, 15
    s_add_u32 s55, s55, 61440
    v_add_u32 v9, s55, v9
    v_mov_b32 v11, 20
    s_mov_b32 s96, 0
Lw_44:
    ds_read_b32 v12, v11
    s_waitcnt lgkmcnt(0)
    v_readfirstlane_b32 s54, v12
    s_cmp_ge_u32 s54, 4
    s_cbranch_scc1 Lwd_45
    s_add_u32 s96, s96, 1
    s_cmp_ge_u32 s96, 0x8000
    s_cbranch_scc1 Lwd_45
    s_sleep 8
    s_branch Lw_44
Lwd_45:
    v_mov_b32 v11, 48
    s_mov_b32 s96, 0
Lw_46:
    ds_read_b32 v12, v11
    s_waitcnt lgkmcnt(0)
    v_readfirstlane_b32 s54, v12
    s_cmp_ge_u32 s54, 5
    s_cbranch_scc1 Lwd_47
    s_add_u32 s96, s96, 1
    s_cmp_ge_u32 s96, 0x8000
    s_cbranch_scc1 Lwd_47
    s_sleep 8
    s_branch Lw_46
Lwd_47:
    s_add_u32 s55, s100, 0
    buffer_load_dwordx2 v[16:17], v2, s[40:43], s55 offen
    s_add_u32 s55, s55, 896
    buffer_load_dwordx2 v[18:19], v2, s[40:43], s55 offen
    s_add_u32 s55, s55, 896
    buffer_load_dwordx2 v[20:21], v2, s[40:43], s55 offen
    s_add_u32 s55, s55, 896
    buffer_load_dwordx2 v[22:23], v2, s[40:43], s55 offen
    s_add_u32 s55, s55, 896
    buffer_load_dwordx2 v[24:25], v2, s[40:43], s55 offen
    s_add_u32 s55, s55, 896
    buffer_load_dwordx2 v[26:27], v2, s[40:43], s55 offen
    s_add_u32 s55, s55, 896
    buffer_load_dwordx2 v[28:29], v2, s[40:43], s55 offen
    s_add_u32 s55, s55, 896
    buffer_load_dwordx2 v[30:31], v2, s[40:43], s55 offen
    s_add_u32 s55, s55, 896
    v_mov_b32 v11, 48
    s_mov_b32 s96, 0
Lw_48:
    ds_read_b32 v12, v11
    s_waitcnt lgkmcnt(0)
    v_readfirstlane_b32 s54, v12
    s_cmp_ge_u32 s54, 5
    s_cbranch_scc1 Lwd_49
    s_add_u32 s96, s96, 1
    s_cmp_ge_u32 s96, 0x8000
    s_cbranch_scc1 Lwd_49
    s_sleep 8
    s_branch Lw_48
Lwd_49:
    s_add_u32 s55, s100, 28672
    buffer_load_dwordx2 v[32:33], v2, s[40:43], s55 offen
    s_add_u32 s55, s55, 896
    buffer_load_dwordx2 v[34:35], v2, s[40:43], s55 offen
    s_add_u32 s55, s55, 896
    buffer_load_dwordx2 v[36:37], v2, s[40:43], s55 offen
    s_add_u32 s55, s55, 896
    buffer_load_dwordx2 v[38:39], v2, s[40:43], s55 offen
    s_add_u32 s55, s55, 896
    buffer_load_dwordx2 v[40:41], v2, s[40:43], s55 offen
    s_add_u32 s55, s55, 896
    buffer_load_dwordx2 v[42:43], v2, s[40:43], s55 offen
    s_add_u32 s55, s55, 896
    buffer_load_dwordx2 v[44:45], v2, s[40:43], s55 offen
    s_add_u32 s55, s55, 896
    buffer_load_dwordx2 v[46:47], v2, s[40:43], s55 offen
    s_add_u32 s55, s55, 896
    s_waitcnt vmcnt(8)
    v_perm_b32 v240, v18, v16, s62
    v_perm_b32 v241, v22, v20, s62
    v_perm_b32 v242, v26, v24, s62
    v_perm_b32 v243, v30, v28, s62
    v_perm_b32 v244, v18, v16, s63
    v_perm_b32 v245, v22, v20, s63
    v_perm_b32 v246, v26, v24, s63
    v_perm_b32 v247, v30, v28, s63
    v_perm_b32 v248, v19, v17, s62
    v_perm_b32 v249, v23, v21, s62
    v_perm_b32 v250, v27, v25, s62
    v_perm_b32 v251, v31, v29, s62
    v_perm_b32 v252, v19, v17, s63
    v_perm_b32 v253, v23, v21, s63
    v_perm_b32 v254, v27, v25, s63
    v_perm_b32 v255, v31, v29, s63
    s_cmp_eq_u32 s35, 3
    s_cbranch_scc1 L_sk_50
    ds_write_b128 v9, v[240:243] offset:0
    ds_write_b128 v9, v[244:247] offset:1024
    ds_write_b128 v9, v[248:251] offset:2048
    ds_write_b128 v9, v[252:255] offset:3072
L_sk_50:
    s_waitcnt lgkmcnt(0)
    v_mov_b32 v11, 48
    s_mov_b32 s96, 0
Lw_51:
    ds_read_b32 v12, v11
    s_waitcnt lgkmcnt(0)
    v_readfirstlane_b32 s54, v12
    s_cmp_ge_u32 s54, 6
    s_cbranch_scc1 Lwd_52
    s_add_u32 s96, s96, 1
    s_cmp_ge_u32 s96, 0x8000
    s_cbranch_scc1 Lwd_52
    s_sleep 8
    s_branch Lw_51
Lwd_52:
    s_add_u32 s55, s100, 57344
    buffer_load_dwordx2 v[48:49], v2, s[40:43], s55 offen
    s_add_u32 s55, s55, 896
    buffer_load_dwordx2 v[50:51], v2, s[40:43], s55 offen
    s_add_u32 s55, s55, 896
    buffer_load_dwordx2 v[52:53], v2, s[40:43], s55 offen
    s_add_u32 s55, s55, 896
    buffer_load_dwordx2 v[54:55], v2, s[40:43], s55 offen
    s_add_u32 s55, s55, 896
    buffer_load_dwordx2 v[56:57], v2, s[40:43], s55 offen
    s_add_u32 s55, s55, 896
    buffer_load_dwordx2 v[58:59], v2, s[40:43], s55 offen
    s_add_u32 s55, s55, 896
    buffer_load_dwordx2 v[60:61], v2, s[40:43], s55 offen
    s_add_u32 s55, s55, 896
    buffer_load_dwordx2 v[62:63], v2, s[40:43], s55 offen
    s_add_u32 s55, s55, 896
    s_waitcnt vmcnt(8)
    v_perm_b32 v240, v34, v32, s62
    v_perm_b32 v241, v38, v36, s62
    v_perm_b32 v242, v42, v40, s62
    v_perm_b32 v243, v46, v44, s62
    v_perm_b32 v244, v34, v32, s63
    v_perm_b32 v245, v38, v36, s63
    v_perm_b32 v246, v42, v40, s63
    v_perm_b32 v247, v46, v44, s63
    v_perm_b32 v248, v35, v33, s62
    v_perm_b32 v249, v39, v37, s62
    v_perm_b32 v250, v43, v41, s62
    v_perm_b32 v251, v47, v45, s62
    v_perm_b32 v252, v35, v33, s63
    v_perm_b32 v253, v39, v37, s63
    v_perm_b32 v254, v43, v41, s63
    v_perm_b32 v255, v47, v45, s63
    s_cmp_eq_u32 s35, 3
    s_cbranch_scc1 L_sk_53
    ds_write_b128 v9, v[240:243] offset:4096
    ds_write_b128 v9, v[244:247] offset:5120
    ds_write_b128 v9, v[248:251] offset:6144
    ds_write_b128 v9, v[252:255] offset:7168
L_sk_53:
    s_waitcnt lgkmcnt(0)
    v_mov_b32 v11, 48
    s_mov_b32 s96, 0
Lw_54:
    ds_read_b32 v12, v11
    s_waitcnt lgkmcnt(0)
    v_readfirstlane_b32 s54, v12
    s_cmp_ge_u32 s54, 6
    s_cbranch_scc1 Lwd_55
    s_add_u32 s96, s96, 1
    s_cmp_ge_u32 s96, 0x8000
    s_cbranch_scc1 Lwd_55
    s_sleep 8
    s_branch Lw_54
Lwd_55:
    s_add_u32 s55, s100, 86016
    buffer_load_dwordx2 v[16:17], v2, s[40:43], s55 offen
    s_add_u32 s55, s55, 896
    buffer_load_dwordx2 v[18:19], v2, s[40:43], s55 offen
    s_add_u32 s55, s55, 896
    buffer_load_dwordx2 v[20:21], v2, s[40:43], s55 offen
    s_add_u32 s55, s55, 896
    buffer_load_dwordx2 v[22:23], v2, s[40:43], s55 offen
    s_add_u32 s55, s55, 896
    buffer_load_dwordx2 v[24:25], v2, s[40:43], s55 offen
    s_add_u32 s55, s55, 896
    buffer_load_dwordx2 v[26:27], v2, s[40:43], s55 offen
    s_add_u32 s55, s55, 896
    buffer_load_dwordx2 v[28:29], v2, s[40:43], s55 offen
    s_add_u32 s55, s55, 896
    buffer_load_dwordx2 v[30:31], v2, s[40:43], s55 offen
    s_add_u32 s55, s55, 896
    s_waitcnt vmcnt(8)
    v_perm_b32 v240, v50, v48, s62
    v_perm_b32 v241, v54, v52, s62
    v_perm_b32 v242, v58, v56, s62
    v_perm_b32 v243, v62, v60, s62
    v_perm_b32 v244, v50, v48, s63
    v_perm_b32 v245, v54, v52, s63
    v_perm_b32 v246, v58, v56, s63
    v_perm_b32 v247, v62, v60, s63
    v_perm_b32 v248, v51, v49, s62
    v_perm_b32 v249, v55, v53, s62
    v_perm_b32 v250, v59, v57, s62
    v_perm_b32 v251, v63, v61, s62
    v_perm_b32 v252, v51, v49, s63
    v_perm_b32 v253, v55, v53, s63
    v_perm_b32 v254, v59, v57, s63
    v_perm_b32 v255, v63, v61, s63
    s_cmp_eq_u32 s35, 3
    s_cbranch_scc1 L_sk_56
    ds_write_b128 v9, v[240:243] offset:8192
    ds_write_b128 v9, v[244:247] offset:9216
    ds_write_b128 v9, v[248:251] offset:10240
    ds_write_b128 v9, v[252:255] offset:11264
L_sk_56:
    s_waitcnt lgkmcnt(0)
    v_mov_b32 v11, 48
    s_mov_b32 s96, 0
Lw_57:
    ds_read_b32 v12, v11
    s_waitcnt lgkmcnt(0)
    v_readfirstlane_b32 s54, v12
    s_cmp_ge_u32 s54, 7
    s_cbranch_scc1 Lwd_58
    s_add_u32 s96, s96, 1
    s_cmp_ge_u32 s96, 0x8000
    s_cbranch_scc1 Lwd_58
    s_sleep 8
    s_branch Lw_57
Lwd_58:
    s_add_u32 s55, s100, 114688
    buffer_load_dwordx2 v[32:33], v2, s[40:43], s55 offen
    s_add_u32 s55, s55, 896
    buffer_load_dwordx2 v[34:35], v2, s[40:43], s55 offen
    s_add_u32 s55, s55, 896
    buffer_load_dwordx2 v[36:37], v2, s[40:43], s55 offen
    s_add_u32 s55, s55, 896
    buffer_load_dwordx2 v[38:39], v2, s[40:43], s55 offen
    s_add_u32 s55, s55, 896
    buffer_load_dwordx2 v[40:41], v2, s[40:43], s55 offen
    s_add_u32 s55, s55, 896
    buffer_load_dwordx2 v[42:43], v2, s[40:43], s55 offen
    s_add_u32 s55, s55, 896
    buffer_load_dwordx2 v[44:45], v2, s[40:43], s55 offen
    s_add_u32 s55, s55, 896
    buffer_load_dwordx2 v[46:47], v2, s[40:43], s55 offen
    s_add_u32 s55, s55, 896
    s_waitcnt vmcnt(8)
    v_perm_b32 v240, v18, v16, s62
    v_perm_b32 v241, v22, v20, s62
    v_perm_b32 v242, v26, v24, s62
    v_perm_b32 v243, v30, v28, s62
    v_perm_b32 v244, v18, v16, s63
    v_perm_b32 v245, v22, v20, s63
    v_perm_b32 v246, v26, v24, s63
    v_perm_b32 v247, v30, v28, s63
    v_perm_b32 v248, v19, v17, s62
    v_perm_b32 v249, v23, v21, s62
    v_perm_b32 v250, v27, v25, s62
    v_perm_b32 v251, v31, v29, s62
    v_perm_b32 v252, v19, v17, s63
    v_perm_b32 v253, v23, v21, s63
    v_perm_b32 v254, v27, v25, s63
    v_perm_b32 v255, v31, v29, s63
    s_cmp_eq_u32 s35, 3
    s_cbranch_scc1 L_sk_59
    ds_write_b128 v9, v[240:243] offset:12288
    ds_write_b128 v9, v[244:247] offset:13312
    ds_write_b128 v9, v[248:251] offset:14336
    ds_write_b128 v9, v[252:255] offset:15360
L_sk_59:
    s_waitcnt lgkmcnt(0)
    v_mov_b32 v11, 48
    s_mov_b32 s96, 0
Lw_60:
    ds_read_b32 v12, v11
    s_waitcnt lgkmcnt(0)
    v_readfirstlane_b32 s54, v12
    s_cmp_ge_u32 s54, 7
    s_cbranch_scc1 Lwd_61
    s_add_u32 s96, s96, 1
    s_cmp_ge_u32 s96, 0x8000
    s_cbranch_scc1 Lwd_61
    s_sleep 8
    s_branch Lw_60
Lwd_61:
    s_add_u32 s55, s100, 143360
    buffer_load_dwordx2 v[48:49], v2, s[40:43], s55 offen
    s_add_u32 s55, s55, 896
    buffer_load_dwordx2 v[50:51], v2, s[40:43], s55 offen
    s_add_u32 s55, s55, 896
    buffer_load_dwordx2 v[52:53], v2, s[40:43], s55 offen
    s_add_u32 s55, s55, 896
    buffer_load_dwordx2 v[54:55], v2, s[40:43], s55 offen
    s_add_u32 s55, s55, 896
    buffer_load_dwordx2 v[56:57], v2, s[40:43], s55 offen
    s_add_u32 s55, s55, 896
    buffer_load_dwordx2 v[58:59], v2, s[40:43], s55 offen
    s_add_u32 s55, s55, 896
    buffer_load_dwordx2 v[60:61], v2, s[40:43], s55 offen
    s_add_u32 s55, s55, 896
    buffer_load_dwordx2 v[62:63], v2, s[40:43], s55 offen
    s_add_u32 s55, s55, 896
    s_waitcnt vmcnt(8)
    v_perm_b32 v240, v34, v32, s62
    v_perm_b32 v241, v38, v36, s62
    v_perm_b32 v242, v42, v40, s62
    v_perm_b32 v243, v46, v44, s62
    v_perm_b32 v244, v34, v32, s63
    v_perm_b32 v245, v38, v36, s63
    v_perm_b32 v246, v42, v40, s63
    v_perm_b32 v247, v46, v44, s63
    v_perm_b32 v248, v35, v33, s62
    v_perm_b32 v249, v39, v37, s62
    v_perm_b32 v250, v43, v41, s62
    v_perm_b32 v251, v47, v45, s62
    v_perm_b32 v252, v35, v33, s63
    v_perm_b32 v253, v39, v37, s63
    v_perm_b32 v254, v43, v41, s63
    v_perm_b32 v255, v47, v45, s63
    s_cmp_eq_u32 s35, 3
    s_cbranch_scc1 L_sk_62
    ds_write_b128 v9, v[240:243] offset:16384
    ds_write_b128 v9, v[244:247] offset:17408
    ds_write_b128 v9, v[248:251] offset:18432
    ds_write_b128 v9, v[252:255] offset:19456
L_sk_62:
    s_waitcnt lgkmcnt(0)
    v_mov_b32 v11, 48
    s_mov_b32 s96, 0
Lw_63:
    ds_read_b32 v12, v11
    s_waitcnt lgkmcnt(0)
    v_readfirstlane_b32 s54, v12
    s_cmp_ge_u32 s54, 8
    s_cbranch_scc1 Lwd_64
    s_add_u32 s96, s96, 1
    s_cmp_ge_u32 s96, 0x8000
    s_cbranch_scc1 Lwd_64
    s_sleep 8
    s_branch Lw_63
Lwd_64:
    s_add_u32 s55, s100, 172032
    buffer_load_dwordx2 v[16:17], v2, s[40:43], s55 offen
    s_add_u32 s55, s55, 896
    buffer_load_dwordx2 v[18:19], v2, s[40:43], s55 offen
    s_add_u32 s55, s55, 896
    buffer_load_dwordx2 v[20:21], v2, s[40:43], s55 offen
    s_add_u32 s55, s55, 896
    buffer_load_dwordx2 v[22:23], v2, s[40:43], s55 offen
    s_add_u32 s55, s55, 896
    buffer_load_dwordx2 v[24:25], v2, s[40:43], s55 offen
    s_add_u32 s55, s55, 896
    buffer_load_dwordx2 v[26:27], v2, s[40:43], s55 offen
    s_add_u32 s55, s55, 896
    buffer_load_dwordx2 v[28:29], v2, s[40:43], s55 offen
    s_add_u32 s55, s55, 896
    buffer_load_dwordx2 v[30:31], v2, s[40:43], s55 offen
    s_add_u32 s55, s55, 896
    s_waitcnt vmcnt(8)
    v_perm_b32 v240, v50, v48, s62
    v_perm_b32 v241, v54, v52, s62
    v_perm_b32 v242, v58, v56, s62
    v_perm_b32 v243, v62, v60, s62
    v_perm_b32 v244, v50, v48, s63
    v_perm_b32 v245, v54, v52, s63
    v_perm_b32 v246, v58, v56, s63
    v_perm_b32 v247, v62, v60, s63
    v_perm_b32 v248, v51, v49, s62
    v_perm_b32 v249, v55, v53, s62
    v_perm_b32 v250, v59, v57, s62
    v_perm_b32 v251, v63, v61, s62
    v_perm_b32 v252, v51, v49, s63
    v_perm_b32 v253, v55, v53, s63
    v_perm_b32 v254, v59, v57, s63
    v_perm_b32 v255, v63, v61, s63
    s_cmp_eq_u32 s35, 3
    s_cbranch_scc1 L_sk_65
    ds_write_b128 v9, v[240:243] offset:20480
    ds_write_b128 v9, v[244:247] offset:21504
    ds_write_b128 v9, v[248:251] offset:22528
    ds_write_b128 v9, v[252:255] offset:23552
L_sk_65:
    s_waitcnt lgkmcnt(0)
    v_mov_b32 v11, 48
    s_mov_b32 s96, 0
Lw_66:
    ds_read_b32 v12, v11
    s_waitcnt lgkmcnt(0)
    v_readfirstlane_b32 s54, v12
    s_cmp_ge_u32 s54, 8
    s_cbranch_scc1 Lwd_67
    s_add_u32 s96, s96, 1
    s_cmp_ge_u32 s96, 0x8000
    s_cbranch_scc1 Lwd_67
    s_sleep 8
    s_branch Lw_66
Lwd_67:
    s_add_u32 s55, s100, 200704
    buffer_load_dwordx2 v[32:33], v2, s[40:43], s55 offen
    s_add_u32 s55, s55, 896
    buffer_load_dwordx2 v[34:35], v2, s[40:43], s55 offen
    s_add_u32 s55, s55, 896
    buffer_load_dwordx2 v[36:37], v2, s[40:43], s55 offen
    s_add_u32 s55, s55, 896
    buffer_load_dwordx2 v[38:39], v2, s[40:43], s55 offen
    s_add_u32 s55, s55, 896
    buffer_load_dwordx2 v[40:41], v2, s[40:43], s55 offen
    s_add_u32 s55, s55, 896
    buffer_load_dwordx2 v[42:43], v2, s[40:43], s55 offen
    s_add_u32 s55, s55, 896
    buffer_load_dwordx2 v[44:45], v2, s[40:43], s55 offen
    s_add_u32 s55, s55, 896
    buffer_load_dwordx2 v[46:47], v2, s[40:43], s55 offen
    s_add_u32 s55, s55, 896
    s_waitcnt vmcnt(8)
    v_perm_b32 v240, v18, v16, s62
    v_perm_b32 v241, v22, v20, s62
    v_perm_b32 v242, v26, v24, s62
    v_perm_b32 v243, v30, v28, s62
    v_perm_b32 v244, v18, v16, s63
    v_perm_b32 v245, v22, v20, s63
    v_perm_b32 v246, v26, v24, s63
    v_perm_b32 v247, v30, v28, s63
    v_perm_b32 v248, v19, v17, s62
    v_perm_b32 v249, v23, v21, s62
    v_perm_b32 v250, v27, v25, s62
    v_perm_b32 v251, v31, v29, s62
    v_perm_b32 v252, v19, v17, s63
    v_perm_b32 v253, v23, v21, s63
    v_perm_b32 v254, v27, v25, s63
    v_perm_b32 v255, v31, v29, s63
    s_cmp_eq_u32 s35, 3
    s_cbranch_scc1 L_sk_68
    ds_write_b128 v9, v[240:243] offset:24576
    ds_write_b128 v9, v[244:247] offset:25600
    ds_write_b128 v9, v[248:251] offset:26624
    ds_write_b128 v9, v[252:255] offset:27648
L_sk_68:
    s_waitcnt lgkmcnt(0)
    v_mov_b32 v11, 48
    s_mov_b32 s96, 0
Lw_69:
    ds_read_b32 v12, v11
    s_waitcnt lgkmcnt(0)
    v_readfirstlane_b32 s54, v12
    s_cmp_ge_u32 s54, 9
    s_cbranch_scc1 Lwd_70
    s_add_u32 s96, s96, 1
    s_cmp_ge_u32 s96, 0x8000
    s_cbranch_scc1 Lwd_70
    s_sleep 8
    s_branch Lw_69
Lwd_70:
    s_add_u32 s55, s98, 0
    buffer_load_dwordx2 v[48:49], v2, s[48:51], s55 offen
    s_add_u32 s55, s55, 896
    buffer_load_dwordx2 v[50:51], v2, s[48:51], s55 offen
    s_add_u32 s55, s55, 896
    buffer_load_dwordx2 v[52:53], v2, s[48:51], s55 offen
    s_add_u32 s55, s55, 896
    buffer_load_dwordx2 v[54:55], v2, s[48:51], s55 offen
    s_add_u32 s55, s55, 896
    buffer_load_dwordx2 v[56:57], v2, s[48:51], s55 offen
    s_add_u32 s55, s55, 896
    buffer_load_dwordx2 v[58:59], v2, s[48:51], s55 offen
    s_add_u32 s55, s55, 896
    buffer_load_dwordx2 v[60:61], v2, s[48:51], s55 offen
    s_add_u32 s55, s55, 896
    buffer_load_dwordx2 v[62:63], v2, s[48:51], s55 offen
    s_add_u32 s55, s55, 896
    s_waitcnt vmcnt(8)
    v_perm_b32 v240, v34, v32, s62
    v_perm_b32 v241, v38, v36, s62
    v_perm_b32 v242, v42, v40, s62
    v_perm_b32 v243, v46, v44, s62
    v_perm_b32 v244, v34, v32, s63
    v_perm_b32 v245, v38, v36, s63
    v_perm_b32 v246, v42, v40, s63
    v_perm_b32 v247, v46, v44, s63
    v_perm_b32 v248, v35, v33, s62
    v_perm_b32 v249, v39, v37, s62
    v_perm_b32 v250, v43, v41, s62
    v_perm_b32 v251, v47, v45, s62
    v_perm_b32 v252, v35, v33, s63
    v_perm_b32 v253, v39, v37, s63
    v_perm_b32 v254, v43, v41, s63
    v_perm_b32 v255, v47, v45, s63
    s_cmp_eq_u32 s35, 3
    s_cbranch_scc1 L_sk_71
    ds_write_b128 v9, v[240:243] offset:28672
    ds_write_b128 v9, v[244:247] offset:29696
    ds_write_b128 v9, v[248:251] offset:30720
    ds_write_b128 v9, v[252:255] offset:31744
L_sk_71:
    s_waitcnt lgkmcnt(0)
    v_mov_b32 v11, 48
    s_mov_b32 s96, 0
Lw_72:
    ds_read_b32 v12, v11
    s_waitcnt lgkmcnt(0)
    v_readfirstlane_b32 s54, v12
    s_cmp_ge_u32 s54, 9
    s_cbranch_scc1 Lwd_73
    s_add_u32 s96, s96, 1
    s_cmp_ge_u32 s96, 0x8000
    s_cbranch_scc1 Lwd_73
    s_sleep 8
    s_branch Lw_72
Lwd_73:
    s_add_u32 s55, s98, 512
    buffer_load_dwordx2 v[16:17], v2, s[48:51], s55 offen
    s_add_u32 s55, s55, 896
    buffer_load_dwordx2 v[18:19], v2, s[48:51], s55 offen
    s_add_u32 s55, s55, 896
    buffer_load_dwordx2 v[20:21], v2, s[48:51], s55 offen
    s_add_u32 s55, s55, 896
    buffer_load_dwordx2 v[22:23], v2, s[48:51], s55 offen
    s_add_u32 s55, s55, 896
    buffer_load_dwordx2 v[24:25], v2, s[48:51], s55 offen
    s_add_u32 s55, s55, 896
    buffer_load_dwordx2 v[26:27], v2, s[48:51], s55 offen
    s_add_u32 s55, s55, 896
    buffer_load_dwordx2 v[28:29], v2, s[48:51], s55 offen
    s_add_u32 s55, s55, 896
    buffer_load_dwordx2 v[30:31], v2, s[48:51], s55 offen
    s_add_u32 s55, s55, 896
    s_waitcnt vmcnt(8)
    v_perm_b32 v240, v50, v48, s62
    v_perm_b32 v241, v54, v52, s62
    v_perm_b32 v242, v58, v56, s62
    v_perm_b32 v243, v62, v60, s62
    v_perm_b32 v244, v50, v48, s63
    v_perm_b32 v245, v54, v52, s63
    v_perm_b32 v246, v58, v56, s63
    v_perm_b32 v247, v62, v60, s63
    v_perm_b32 v248, v51, v49, s62
    v_perm_b32 v249, v55, v53, s62
    v_perm_b32 v250, v59, v57, s62
    v_perm_b32 v251, v63, v61, s62
    v_perm_b32 v252, v51, v49, s63
    v_perm_b32 v253, v55, v53, s63
    v_perm_b32 v254, v59, v57, s63
    v_perm_b32 v255, v63, v61, s63
    ds_write_b128 v10, v[240:243] offset:0
    ds_write_b128 v10, v[244:247] offset:1024
    ds_write_b128 v10, v[248:251] offset:2048
    ds_write_b128 v10, v[252:255] offset:3072
    s_waitcnt lgkmcnt(0)
    v_mov_b32 v11, 48
    s_mov_b32 s96, 0
Lw_74:
    ds_read_b32 v12, v11
    s_waitcnt lgkmcnt(0)
    v_readfirstlane_b32 s54, v12
    s_cmp_ge_u32 s54, 10
    s_cbranch_scc1 Lwd_75
    s_add_u32 s96, s96, 1
    s_cmp_ge_u32 s96, 0x8000
    s_cbranch_scc1 Lwd_75
    s_sleep 8
    s_branch Lw_74
Lwd_75:
    s_add_u32 s55, s99, 0
    buffer_load_dword v32, v8, s[44:47], s55 offen
    s_add_u32 s55, s55, 3584
    buffer_load_dword v33, v8, s[44:47], s55 offen
    s_add_u32 s55, s55, 3584
    buffer_load_dword v34, v8, s[44:47], s55 offen
    s_add_u32 s55, s55, 3584
    buffer_load_dword v35, v8, s[44:47], s55 offen
    s_add_u32 s55, s55, 3584
    buffer_load_dword v36, v8, s[44:47], s55 offen
    s_add_u32 s55, s55, 3584
    buffer_load_dword v37, v8, s[44:47], s55 offen
    s_add_u32 s55, s55, 3584
    buffer_load_dword v38, v8, s[44:47], s55 offen
    s_add_u32 s55, s55, 3584
    buffer_load_dword v39, v8, s[44:47], s55 offen
    s_add_u32 s55, s55, 3584
    s_waitcnt vmcnt(8)
    v_perm_b32 v240, v18, v16, s62
    v_perm_b32 v241, v22, v20, s62
    v_perm_b32 v242, v26, v24, s62
    v_perm_b32 v243, v30, v28, s62
    v_perm_b32 v244, v18, v16, s63
    v_perm_b32 v245, v22, v20, s63
    v_perm_b32 v246, v26, v24, s63
    v_perm_b32 v247, v30, v28, s63
    v_perm_b32 v248, v19, v17, s62
    v_perm_b32 v249, v23, v21, s62
    v_perm_b32 v250, v27, v25, s62
    v_perm_b32 v251, v31, v29, s62
    v_perm_b32 v252, v19, v17, s63
    v_perm_b32 v253, v23, v21, s63
    v_perm_b32 v254, v27, v25, s63
    v_perm_b32 v255, v31, v29, s63
    s_cmp_eq_u32 s35, 3
    s_cbranch_scc1 L_sk_76
    ds_write_b128 v10, v[240:243] offset:16384
    ds_write_b128 v10, v[244:247] offset:17408
    ds_write_b128 v10, v[248:251] offset:18432
    ds_write_b128 v10, v[252:255] offset:19456
L_sk_76:
    s_waitcnt lgkmcnt(0)
    v_mov_b32 v11, 48
    s_mov_b32 s96, 0
Lw_77:
    ds_read_b32 v12, v11
    s_waitcnt lgkmcnt(0)
    v_readfirstlane_b32 s54, v12
    s_cmp_ge_u32 s54, 10
    s_cbranch_scc1 Lwd_78
    s_add_u32 s96, s96, 1
    s_cmp_ge_u32 s96, 0x8000
    s_cbranch_scc1 Lwd_78
    s_sleep 8
    s_branch Lw_77
Lwd_78:
    s_add_u32 s55, s99, 114688
    buffer_load_dword v48, v8, s[44:47], s55 offen
    s_add_u32 s55, s55, 3584
    buffer_load_dword v49, v8, s[44:47], s55 offen
    s_add_u32 s55, s55, 3584
    buffer_load_dword v50, v8, s[44:47], s55 offen
    s_add_u32 s55, s55, 3584
    buffer_load_dword v51, v8, s[44:47], s55 offen
    s_add_u32 s55, s55, 3584
    buffer_load_dword v52, v8, s[44:47], s55 offen
    s_add_u32 s55, s55, 3584
    buffer_load_dword v53, v8, s[44:47], s55 offen
    s_add_u32 s55, s55, 3584
    buffer_load_dword v54, v8, s[44:47], s55 offen
    s_add_u32 s55, s55, 3584
    buffer_load_dword v55, v8, s[44:47], s55 offen
    s_add_u32 s55, s55, 3584
    s_waitcnt vmcnt(8)
    v_perm_b32 v72, v33, v32, s62
    v_perm_b32 v73, v35, v34, s62
    v_perm_b32 v74, v37, v36, s62
    v_perm_b32 v75, v39, v38, s62
    v_perm_b32 v76, v33, v32, s63
    v_perm_b32 v77, v35, v34, s63
    v_perm_b32 v78, v37, v36, s63
    v_perm_b32 v79, v39, v38, s63
    v_mov_b32 v11, 48
    s_mov_b32 s96, 0
Lw_79:
    ds_read_b32 v12, v11
    s_waitcnt lgkmcnt(0)
    v_readfirstlane_b32 s54, v12
    s_cmp_ge_u32 s54, 11
    s_cbranch_scc1 Lwd_80
    s_add_u32 s96, s96, 1
    s_cmp_ge_u32 s96, 0x8000
    s_cbranch_scc1 Lwd_80
    s_sleep 8
    s_branch Lw_79
Lwd_80:
    s_add_u32 s55, s99, 229376
    buffer_load_dword v16, v8, s[44:47], s55 offen
    s_add_u32 s55, s55, 3584
    buffer_load_dword v17, v8, s[44:47], s55 offen
    s_add_u32 s55, s55, 3584
    buffer_load_dword v18, v8, s[44:47], s55 offen
    s_add_u32 s55, s55, 3584
    buffer_load_dword v19, v8, s[44:47], s55 offen
    s_add_u32 s55, s55, 3584
    buffer_load_dword v20, v8, s[44:47], s55 offen
    s_add_u32 s55, s55, 3584
    buffer_load_dword v21, v8, s[44:47], s55 offen
    s_add_u32 s55, s55, 3584
    buffer_load_dword v22, v8, s[44:47], s55 offen
    s_add_u32 s55, s55, 3584
    buffer_load_dword v23, v8, s[44:47], s55 offen
    s_add_u32 s55, s55, 3584
    s_waitcnt vmcnt(8)
    v_perm_b32 v80, v49, v48, s62
    v_perm_b32 v81, v51, v50, s62
    v_perm_b32 v82, v53, v52, s62
    v_perm_b32 v83, v55, v54, s62
    v_perm_b32 v84, v49, v48, s63
    v_perm_b32 v85, v51, v50, s63
    v_perm_b32 v86, v53, v52, s63
    v_perm_b32 v87, v55, v54, s63
    v_mov_b32 v11, 48
    s_mov_b32 s96, 0
Lw_81:
    ds_read_b32 v12, v11
    s_waitcnt lgkmcnt(0)
    v_readfirstlane_b32 s54, v12
    s_cmp_ge_u32 s54, 11
    s_cbranch_scc1 Lwd_82
    s_add_u32 s96, s96, 1
    s_cmp_ge_u32 s96, 0x8000
    s_cbranch_scc1 Lwd_82
    s_sleep 8
    s_branch Lw_81
Lwd_82:
    s_add_u32 s55, s99, 344064
    buffer_load_dword v32, v8, s[44:47], s55 offen
    s_add_u32 s55, s55, 3584
    buffer_load_dword v33, v8, s[44:47], s55 offen
    s_add_u32 s55, s55, 3584
    buffer_load_dword v34, v8, s[44:47], s55 offen
    s_add_u32 s55, s55, 3584
    buffer_load_dword v35, v8, s[44:47], s55 offen
    s_add_u32 s55, s55, 3584
    buffer_load_dword v36, v8, s[44:47], s55 offen
    s_add_u32 s55, s55, 3584
    buffer_load_dword v37, v8, s[44:47], s55 offen
    s_add_u32 s55, s55, 3584
    buffer_load_dword v38, v8, s[44:47], s55 offen
    s_add_u32 s55, s55, 3584
    buffer_load_dword v39, v8, s[44:47], s55 offen
    s_add_u32 s55, s55, 3584
    s_waitcnt vmcnt(8)
    v_perm_b32 v88, v17, v16, s62
    v_perm_b32 v89, v19, v18, s62
    v_perm_b32 v90, v21, v20, s62
    v_perm_b32 v91, v23, v22, s62
    v_perm_b32 v92, v17, v16, s63
    v_perm_b32 v93, v19, v18, s63
    v_perm_b32 v94, v21, v20, s63
    v_perm_b32 v95, v23, v22, s63
    v_mov_b32 v11, 48
    s_mov_b32 s96, 0
Lw_83:
    ds_read_b32 v12, v11
    s_waitcnt lgkmcnt(0)
    v_readfirstlane_b32 s54, v12
    s_cmp_ge_u32 s54, 12
    s_cbranch_scc1 Lwd_84
    s_add_u32 s96, s96, 1
    s_cmp_ge_u32 s96, 0x8000
    s_cbranch_scc1 Lwd_84
    s_sleep 8
    s_branch Lw_83
Lwd_84:
    s_add_u32 s55, s99, 458752
    buffer_load_dword v48, v8, s[44:47], s55 offen
    s_add_u32 s55, s55, 3584
    buffer_load_dword v49, v8, s[44:47], s55 offen
    s_add_u32 s55, s55, 3584
    buffer_load_dword v50, v8, s[44:47], s55 offen
    s_add_u32 s55, s55, 3584
    buffer_load_dword v51, v8, s[44:47], s55 offen
    s_add_u32 s55, s55, 3584
    buffer_load_dword v52, v8, s[44:47], s55 offen
    s_add_u32 s55, s55, 3584
    buffer_load_dword v53, v8, s[44:47], s55 offen
    s_add_u32 s55, s55, 3584
    buffer_load_dword v54, v8, s[44:47], s55 offen
    s_add_u32 s55, s55, 3584
    buffer_load_dword v55, v8, s[44:47], s55 offen
    s_add_u32 s55, s55, 3584
    s_waitcnt vmcnt(8)
    v_perm_b32 v96, v33, v32, s62
    v_perm_b32 v97, v35, v34, s62
    v_perm_b32 v98, v37, v36, s62
    v_perm_b32 v99, v39, v38, s62
    v_perm_b32 v100, v33, v32, s63
    v_perm_b32 v101, v35, v34, s63
    v_perm_b32 v102, v37, v36, s63
    v_perm_b32 v103, v39, v38, s63
    v_mov_b32 v11, 48
    s_mov_b32 s96, 0
Lw_85:
    ds_read_b32 v12, v11
    s_waitcnt lgkmcnt(0)
    v_readfirstlane_b32 s54, v12
    s_cmp_ge_u32 s54, 12
    s_cbranch_scc1 Lwd_86
    s_add_u32 s96, s96, 1
    s_cmp_ge_u32 s96, 0x8000
    s_cbranch_scc1 Lwd_86
    s_sleep 8
    s_branch Lw_85
Lwd_86:
    s_add_u32 s55, s99, 573440
    buffer_load_dword v16, v8, s[44:47], s55 offen
    s_add_u32 s55, s55, 3584
    buffer_load_dword v17, v8, s[44:47], s55 offen
    s_add_u32 s55, s55, 3584
    buffer_load_dword v18, v8, s[44:47], s55 offen
    s_add_u32 s55, s55, 3584
    buffer_load_dword v19, v8, s[44:47], s55 offen
    s_add_u32 s55, s55, 3584
    buffer_load_dword v20, v8, s[44:47], s55 offen
    s_add_u32 s55, s55, 3584
    buffer_load_dword v21, v8, s[44:47], s55 offen
    s_add_u32 s55, s55, 3584
    buffer_load_dword v22, v8, s[44:47], s55 offen
    s_add_u32 s55, s55, 3584
    buffer_load_dword v23, v8, s[44:47], s55 offen
    s_add_u32 s55, s55, 3584
    s_waitcnt vmcnt(8)
    v_perm_b32 v104, v49, v48, s62
    v_perm_b32 v105, v51, v50, s62
    v_perm_b32 v106, v53, v52, s62
    v_perm_b32 v107, v55, v54, s62
    v_perm_b32 v108, v49, v48, s63
    v_perm_b32 v109, v51, v50, s63
    v_perm_b32 v110, v53, v52, s63
    v_perm_b32 v111, v55, v54, s63
    v_mov_b32 v11, 48
    s_mov_b32 s96, 0
Lw_87:
    ds_read_b32 v12, v11
    s_waitcnt lgkmcnt(0)
    v_readfirstlane_b32 s54, v12
    s_cmp_ge_u32 s54, 13
    s_cbranch_scc1 Lwd_88
    s_add_u32 s96, s96, 1
    s_cmp_ge_u32 s96, 0x8000
    s_cbranch_scc1 Lwd_88
    s_sleep 8
    s_branch Lw_87
Lwd_88:
    s_add_u32 s55, s99, 688128
    buffer_load_dword v32, v8, s[44:47], s55 offen
    s_add_u32 s55, s55, 3584
    buffer_load_dword v33, v8, s[44:47], s55 offen
    s_add_u32 s55, s55, 3584
    buffer_load_dword v34, v8, s[44:47], s55 offen
    s_add_u32 s55, s55, 3584
    buffer_load_dword v35, v8, s[44:47], s55 offen
    s_add_u32 s55, s55, 3584
    buffer_load_dword v36, v8, s[44:47], s55 offen
    s_add_u32 s55, s55, 3584
    buffer_load_dword v37, v8, s[44:47], s55 offen
    s_add_u32 s55, s55, 3584
    buffer_load_dword v38, v8, s[44:47], s55 offen
    s_add_u32 s55, s55, 3584
    buffer_load_dword v39, v8, s[44:47], s55 offen
    s_add_u32 s55, s55, 3584
    s_waitcnt vmcnt(8)
    v_perm_b32 v112, v17, v16, s62
    v_perm_b32 v113, v19, v18, s62
    v_perm_b32 v114, v21, v20, s62
    v_perm_b32 v115, v23, v22, s62
    v_perm_b32 v116, v17, v16, s63
    v_perm_b32 v117, v19, v18, s63
    v_perm_b32 v118, v21, v20, s63
    v_perm_b32 v119, v23, v22, s63
    v_mov_b32 v11, 48
    s_mov_b32 s96, 0
Lw_89:
    ds_read_b32 v12, v11
    s_waitcnt lgkmcnt(0)
    v_readfirstlane_b32 s54, v12
    s_cmp_ge_u32 s54, 13
    s_cbranch_scc1 Lwd_90
    s_add_u32 s96, s96, 1
    s_cmp_ge_u32 s96, 0x8000
    s_cbranch_scc1 Lwd_90
    s_sleep 8
    s_branch Lw_89
Lwd_90:
    s_add_u32 s55, s101, 0
    buffer_load_dwordx2 v[48:49], v2, s[40:43], s55 offen
    s_add_u32 s55, s55, 896
    buffer_load_dwordx2 v[50:51], v2, s[40:43], s55 offen
    s_add_u32 s55, s55, 896
    buffer_load_dwordx2 v[52:53], v2, s[40:43], s55 offen
    s_add_u32 s55, s55, 896
    buffer_load_dwordx2 v[54:55], v2, s[40:43], s55 offen
    s_add_u32 s55, s55, 896
    buffer_load_dwordx2 v[56:57], v2, s[40:43], s55 offen
    s_add_u32 s55, s55, 896
    buffer_load_dwordx2 v[58:59], v2, s[40:43], s55 offen
    s_add_u32 s55, s55, 896
    buffer_load_dwordx2 v[60:61], v2, s[40:43], s55 offen
    s_add_u32 s55, s55, 896
    buffer_load_dwordx2 v[62:63], v2, s[40:43], s55 offen
    s_add_u32 s55, s55, 896
    s_waitcnt vmcnt(8)
    v_perm_b32 v120, v33, v32, s62
    v_perm_b32 v121, v35, v34, s62
    v_perm_b32 v122, v37, v36, s62
    v_perm_b32 v123, v39, v38, s62
    v_perm_b32 v124, v33, v32, s63
    v_perm_b32 v125, v35, v34, s63
    v_perm_b32 v126, v37, v36, s63
    v_perm_b32 v127, v39, v38, s63
    v_mov_b32 v11, 48
    s_mov_b32 s96, 0
Lw_91:
    ds_read_b32 v12, v11
    s_waitcnt lgkmcnt(0)
    v_readfirstlane_b32 s54, v12
    s_cmp_ge_u32 s54, 14
    s_cbranch_scc1 Lwd_92
    s_add_u32 s96, s96, 1
    s_cmp_ge_u32 s96, 0x8000
    s_cbranch_scc1 Lwd_92
    s_sleep 8
    s_branch Lw_91
Lwd_92:
    s_add_u32 s55, s101, 28672
    buffer_load_dwordx2 v[16:17], v2, s[40:43], s55 offen
    s_add_u32 s55, s55, 896
    buffer_load_dwordx2 v[18:19], v2, s[40:43], s55 offen
    s_add_u32 s55, s55, 896
    buffer_load_dwordx2 v[20:21], v2, s[40:43], s55 offen
    s_add_u32 s55, s55, 896
    buffer_load_dwordx2 v[22:23], v2, s[40:43], s55 offen
    s_add_u32 s55, s55, 896
    buffer_load_dwordx2 v[24:25], v2, s[40:43], s55 offen
    s_add_u32 s55, s55, 896
    buffer_load_dwordx2 v[26:27], v2, s[40:43], s55 offen
    s_add_u32 s55, s55, 896
    buffer_load_dwordx2 v[28:29], v2, s[40:43], s55 offen
    s_add_u32 s55, s55, 896
    buffer_load_dwordx2 v[30:31], v2, s[40:43], s55 offen
    s_add_u32 s55, s55, 896
    s_waitcnt vmcnt(8)
    v_perm_b32 v128, v50, v48, s62
    v_perm_b32 v129, v54, v52, s62
    v_perm_b32 v130, v58, v56, s62
    v_perm_b32 v131, v62, v60, s62
    v_perm_b32 v132, v50, v48, s63
    v_perm_b32 v133, v54, v52, s63
    v_perm_b32 v134, v58, v56, s63
    v_perm_b32 v135, v62, v60, s63
    v_perm_b32 v136, v51, v49, s62
    v_perm_b32 v137, v55, v53, s62
    v_perm_b32 v138, v59, v57, s62
    v_perm_b32 v139, v63, v61, s62
    v_perm_b32 v140, v51, v49, s63
    v_perm_b32 v141, v55, v53, s63
    v_perm_b32 v142, v59, v57, s63
    v_perm_b32 v143, v63, v61, s63
    v_mov_b32 v11, 48
    s_mov_b32 s96, 0
Lw_93:
    ds_read_b32 v12, v11
    s_waitcnt lgkmcnt(0)
    v_readfirstlane_b32 s54, v12
    s_cmp_ge_u32 s54, 14
    s_cbranch_scc1 Lwd_94
    s_add_u32 s96, s96, 1
    s_cmp_ge_u32 s96, 0x8000
    s_cbranch_scc1 Lwd_94
    s_sleep 8
    s_branch Lw_93
Lwd_94:
    s_add_u32 s55, s101, 57344
    buffer_load_dwordx2 v[32:33], v2, s[40:43], s55 offen
    s_add_u32 s55, s55, 896
    buffer_load_dwordx2 v[34:35], v2, s[40:43], s55 offen
    s_add_u32 s55, s55, 896
    buffer_load_dwordx2 v[36:37], v2, s[40:43], s55 offen
    s_add_u32 s55, s55, 896
    buffer_load_dwordx2 v[38:39], v2, s[40:43], s55 offen
    s_add_u32 s55, s55, 896
    buffer_load_dwordx2 v[40:41], v2, s[40:43], s55 offen
    s_add_u32 s55, s55, 896
    buffer_load_dwordx2 v[42:43], v2, s[40:43], s55 offen
    s_add_u32 s55, s55, 896
    buffer_load_dwordx2 v[44:45], v2, s[40:43], s55 offen
    s_add_u32 s55, s55, 896
    buffer_load_dwordx2 v[46:47], v2, s[40:43], s55 offen
    s_add_u32 s55, s55, 896
    s_waitcnt vmcnt(8)
    v_perm_b32 v144, v18, v16, s62
    v_perm_b32 v145, v22, v20, s62
    v_perm_b32 v146, v26, v24, s62
    v_perm_b32 v147, v30, v28, s62
    v_perm_b32 v148, v18, v16, s63
    v_perm_b32 v149, v22, v20, s63
    v_perm_b32 v150, v26, v24, s63
    v_perm_b32 v151, v30, v28, s63
    v_perm_b32 v152, v19, v17, s62
    v_perm_b32 v153, v23, v21, s62
    v_perm_b32 v154, v27, v25, s62
    v_perm_b32 v155, v31, v29, s62
    v_perm_b32 v156, v19, v17, s63
    v_perm_b32 v157, v23, v21, s63
    v_perm_b32 v158, v27, v25, s63
    v_perm_b32 v159, v31, v29, s63
    v_mov_b32 v11, 48
    s_mov_b32 s96, 0
Lw_95:
    ds_read_b32 v12, v11
    s_waitcnt lgkmcnt(0)
    v_readfirstlane_b32 s54, v12
    s_cmp_ge_u32 s54, 15
    s_cbranch_scc1 Lwd_96
    s_add_u32 s96, s96, 1
    s_cmp_ge_u32 s96, 0x8000
    s_cbranch_scc1 Lwd_96
    s_sleep 8
    s_branch Lw_95
Lwd_96:
    s_add_u32 s55, s101, 86016
    buffer_load_dwordx2 v[48:49], v2, s[40:43], s55 offen
    s_add_u32 s55, s55, 896
    buffer_load_dwordx2 v[50:51], v2, s[40:43], s55 offen
    s_add_u32 s55, s55, 896
    buffer_load_dwordx2 v[52:53], v2, s[40:43], s55 offen
    s_add_u32 s55, s55, 896
    buffer_load_dwordx2 v[54:55], v2, s[40:43], s55 offen
    s_add_u32 s55, s55, 896
    buffer_load_dwordx2 v[56:57], v2, s[40:43], s55 offen
    s_add_u32 s55, s55, 896
    buffer_load_dwordx2 v[58:59], v2, s[40:43], s55 offen
    s_add_u32 s55, s55, 896
    buffer_load_dwordx2 v[60:61], v2, s[40:43], s55 offen
    s_add_u32 s55, s55, 896
    buffer_load_dwordx2 v[62:63], v2, s[40:43], s55 offen
    s_add_u32 s55, s55, 896
    s_waitcnt vmcnt(8)
    v_perm_b32 v160, v34, v32, s62
    v_perm_b32 v161, v38, v36, s62
    v_perm_b32 v162, v42, v40, s62
    v_perm_b32 v163, v46, v44, s62
    v_perm_b32 v164, v34, v32, s63
    v_perm_b32 v165, v38, v36, s63
    v_perm_b32 v166, v42, v40, s63
    v_perm_b32 v167, v46, v44, s63
    v_perm_b32 v168, v35, v33, s62
    v_perm_b32 v169, v39, v37, s62
    v_perm_b32 v170, v43, v41, s62
    v_perm_b32 v171, v47, v45, s62
    v_perm_b32 v172, v35, v33, s63
    v_perm_b32 v173, v39, v37, s63
    v_perm_b32 v174, v43, v41, s63
    v_perm_b32 v175, v47, v45, s63
    v_mov_b32 v11, 48
    s_mov_b32 s96, 0
Lw_97:
    ds_read_b32 v12, v11
    s_waitcnt lgkmcnt(0)
    v_readfirstlane_b32 s54, v12
    s_cmp_ge_u32 s54, 15
    s_cbranch_scc1 Lwd_98
    s_add_u32 s96, s96, 1
    s_cmp_ge_u32 s96, 0x8000
    s_cbranch_scc1 Lwd_98
    s_sleep 8
    s_branch Lw_97
Lwd_98:
    s_add_u32 s55, s101, 114688
    buffer_load_dwordx2 v[16:17], v2, s[40:43], s55 offen
    s_add_u32 s55, s55, 896
    buffer_load_dwordx2 v[18:19], v2, s[40:43], s55 offen
    s_add_u32 s55, s55, 896
    buffer_load_dwordx2 v[20:21], v2, s[40:43], s55 offen
    s_add_u32 s55, s55, 896
    buffer_load_dwordx2 v[22:23], v2, s[40:43], s55 offen
    s_add_u32 s55, s55, 896
    buffer_load_dwordx2 v[24:25], v2, s[40:43], s55 offen
    s_add_u32 s55, s55, 896
    buffer_load_dwordx2 v[26:27], v2, s[40:43], s55 offen
    s_add_u32 s55, s55, 896
    buffer_load_dwordx2 v[28:29], v2, s[40:43], s55 offen
    s_add_u32 s55, s55, 896
    buffer_load_dwordx2 v[30:31], v2, s[40:43], s55 offen
    s_add_u32 s55, s55, 896
    s_waitcnt vmcnt(8)
    v_perm_b32 v176, v50, v48, s62
    v_perm_b32 v177, v54, v52, s62
    v_perm_b32 v178, v58, v56, s62
    v_perm_b32 v179, v62, v60, s62
    v_perm_b32 v180, v50, v48, s63
    v_perm_b32 v181, v54, v52, s63
    v_perm_b32 v182, v58, v56, s63
    v_perm_b32 v183, v62, v60, s63
    v_perm_b32 v184, v51, v49, s62
    v_perm_b32 v185, v55, v53, s62
    v_perm_b32 v186, v59, v57, s62
    v_perm_b32 v187, v63, v61, s62
    v_perm_b32 v188, v51, v49, s63
    v_perm_b32 v189, v55, v53, s63
    v_perm_b32 v190, v59, v57, s63
    v_perm_b32 v191, v63, v61, s63
    v_mov_b32 v11, 48
    s_mov_b32 s96, 0
Lw_99:
    ds_read_b32 v12, v11
    s_waitcnt lgkmcnt(0)
    v_readfirstlane_b32 s54, v12
    s_cmp_ge_u32 s54, 16
    s_cbranch_scc1 Lwd_100
    s_add_u32 s96, s96, 1
    s_cmp_ge_u32 s96, 0x8000
    s_cbranch_scc1 Lwd_100
    s_sleep 8
    s_branch Lw_99
Lwd_100:
    s_add_u32 s55, s101, 143360
    buffer_load_dwordx2 v[32:33], v2, s[40:43], s55 offen
    s_add_u32 s55, s55, 896
    buffer_load_dwordx2 v[34:35], v2, s[40:43], s55 offen
    s_add_u32 s55, s55, 896
    buffer_load_dwordx2 v[36:37], v2, s[40:43], s55 offen
    s_add_u32 s55, s55, 896
    buffer_load_dwordx2 v[38:39], v2, s[40:43], s55 offen
    s_add_u32 s55, s55, 896
    buffer_load_dwordx2 v[40:41], v2, s[40:43], s55 offen
    s_add_u32 s55, s55, 896
    buffer_load_dwordx2 v[42:43], v2, s[40:43], s55 offen
    s_add_u32 s55, s55, 896
    buffer_load_dwordx2 v[44:45], v2, s[40:43], s55 offen
    s_add_u32 s55, s55, 896
    buffer_load_dwordx2 v[46:47], v2, s[40:43], s55 offen
    s_add_u32 s55, s55, 896
    s_waitcnt vmcnt(8)
    v_perm_b32 v192, v18, v16, s62
    v_perm_b32 v193, v22, v20, s62
    v_perm_b32 v194, v26, v24, s62
    v_perm_b32 v195, v30, v28, s62
    v_perm_b32 v196, v18, v16, s63
    v_perm_b32 v197, v22, v20, s63
    v_perm_b32 v198, v26, v24, s63
    v_perm_b32 v199, v30, v28, s63
    v_perm_b32 v200, v19, v17, s62
    v_perm_b32 v201, v23, v21, s62
    v_perm_b32 v202, v27, v25, s62
    v_perm_b32 v203, v31, v29, s62
    v_perm_b32 v204, v19, v17, s63
    v_perm_b32 v205, v23, v21, s63
    v_perm_b32 v206, v27, v25, s63
    v_perm_b32 v207, v31, v29, s63
    v_mov_b32 v11, 48
    s_mov_b32 s96, 0
Lw_101:
    ds_read_b32 v12, v11
    s_waitcnt lgkmcnt(0)
    v_readfirstlane_b32 s54, v12
    s_cmp_ge_u32 s54, 16
    s_cbranch_scc1 Lwd_102
    s_add_u32 s96, s96, 1
    s_cmp_ge_u32 s96, 0x8000
    s_cbranch_scc1 Lwd_102
    s_sleep 8
    s_branch Lw_101
Lwd_102:
    s_add_u32 s55, s101, 172032
    buffer_load_dwordx2 v[48:49], v2, s[40:43], s55 offen
    s_add_u32 s55, s55, 896
    buffer_load_dwordx2 v[50:51], v2, s[40:43], s55 offen
    s_add_u32 s55, s55, 896
    buffer_load_dwordx2 v[52:53], v2, s[40:43], s55 offen
    s_add_u32 s55, s55, 896
    buffer_load_dwordx2 v[54:55], v2, s[40:43], s55 offen
    s_add_u32 s55, s55, 896
    buffer_load_dwordx2 v[56:57], v2, s[40:43], s55 offen
    s_add_u32 s55, s55, 896
    buffer_load_dwordx2 v[58:59], v2, s[40:43], s55 offen
    s_add_u32 s55, s55, 896
    buffer_load_dwordx2 v[60:61], v2, s[40:43], s55 offen
    s_add_u32 s55, s55, 896
    buffer_load_dwordx2 v[62:63], v2, s[40:43], s55 offen
    s_add_u32 s55, s55, 896
    s_waitcnt vmcnt(8)
    v_perm_b32 v208, v34, v32, s62
    v_perm_b32 v209, v38, v36, s62
    v_perm_b32 v210, v42, v40, s62
    v_perm_b32 v211, v46, v44, s62
    v_perm_b32 v212, v34, v32, s63
    v_perm_b32 v213, v38, v36, s63
    v_perm_b32 v214, v42, v40, s63
    v_perm_b32 v215, v46, v44, s63
    v_perm_b32 v216, v35, v33, s62
    v_perm_b32 v217, v39, v37, s62
    v_perm_b32 v218, v43, v41, s62
    v_perm_b32 v219, v47, v45, s62
    v_perm_b32 v220, v35, v33, s63
    v_perm_b32 v221, v39, v37, s63
    v_perm_b32 v222, v43, v41, s63
    v_perm_b32 v223, v47, v45, s63
    v_mov_b32 v11, 48
    s_mov_b32 s96, 0
Lw_103:
    ds_read_b32 v12, v11
    s_waitcnt lgkmcnt(0)
    v_readfirstlane_b32 s54, v12
    s_cmp_ge_u32 s54, 17
    s_cbranch_scc1 Lwd_104
    s_add_u32 s96, s96, 1
    s_cmp_ge_u32 s96, 0x8000
    s_cbranch_scc1 Lwd_104
    s_sleep 8
    s_branch Lw_103
Lwd_104:
    s_add_u32 s55, s101, 200704
    buffer_load_dwordx2 v[16:17], v2, s[40:43], s55 offen
    s_add_u32 s55, s55, 896
    buffer_load_dwordx2 v[18:19], v2, s[40:43], s55 offen
    s_add_u32 s55, s55, 896
    buffer_load_dwordx2 v[20:21], v2, s[40:43], s55 offen
    s_add_u32 s55, s55, 896
    buffer_load_dwordx2 v[22:23], v2, s[40:43], s55 offen
    s_add_u32 s55, s55, 896
    buffer_load_dwordx2 v[24:25], v2, s[40:43], s55 offen
    s_add_u32 s55, s55, 896
    buffer_load_dwordx2 v[26:27], v2, s[40:43], s55 offen
    s_add_u32 s55, s55, 896
    buffer_load_dwordx2 v[28:29], v2, s[40:43], s55 offen
    s_add_u32 s55, s55, 896
    buffer_load_dwordx2 v[30:31], v2, s[40:43], s55 offen
    s_add_u32 s55, s55, 896
    s_waitcnt vmcnt(8)
    v_perm_b32 v224, v50, v48, s62
    v_perm_b32 v225, v54, v52, s62
    v_perm_b32 v226, v58, v56, s62
    v_perm_b32 v227, v62, v60, s62
    v_perm_b32 v228, v50, v48, s63
    v_perm_b32 v229, v54, v52, s63
    v_perm_b32 v230, v58, v56, s63
    v_perm_b32 v231, v62, v60, s63
    v_perm_b32 v232, v51, v49, s62
    v_perm_b32 v233, v55, v53, s62
    v_perm_b32 v234, v59, v57, s62
    v_perm_b32 v235, v63, v61, s62
    v_perm_b32 v236, v51, v49, s63
    v_perm_b32 v237, v55, v53, s63
    v_perm_b32 v238, v59, v57, s63
    v_perm_b32 v239, v63, v61, s63
    s_waitcnt vmcnt(0)
    v_perm_b32 v240, v18, v16, s62
    v_perm_b32 v241, v22, v20, s62
    v_perm_b32 v242, v26, v24, s62
    v_perm_b32 v243, v30, v28, s62
    v_perm_b32 v244, v18, v16, s63
    v_perm_b32 v245, v22, v20, s63
    v_perm_b32 v246, v26, v24, s63
    v_perm_b32 v247, v30, v28, s63
    v_perm_b32 v248, v19, v17, s62
    v_perm_b32 v249, v23, v21, s62
    v_perm_b32 v250, v27, v25, s62
    v_perm_b32 v251, v31, v29, s62
    v_perm_b32 v252, v19, v17, s63
    v_perm_b32 v253, v23, v21, s63
    v_perm_b32 v254, v27, v25, s63
    v_perm_b32 v255, v31, v29, s63
    s_waitcnt lgkmcnt(0)
    v_mov_b32 v11, 16
    v_mov_b32 v12, 1
    s_mov_b64 exec, 1
    ds_add_u32 v11, v12
    s_mov_b64 exec, -1
    s_mov_b32 s48, s4
    s_mov_b32 s49, s5
    s_mov_b32 s50, 0x1c00
    s_mov_b32 s51, 0x00020000
    s_cmp_lg_u32 s35, 3
    s_cbranch_scc1 L_tp_nor1
    s_and_b32 s59, s2, 31
    s_cmp_ge_u32 s59, 28
    s_cbranch_scc1 L_tp_nor1
    s_mul_i32 s55, s33, 21504
    s_lshr_b32 s56, s59, 2
    s_lshl_b32 s56, s56, 9
    s_add_u32 s55, s55, s56
    s_and_b32 s56, s59, 3
    s_lshl_b32 s56, s56, 5
    s_add_u32 s55, s55, s56
    s_add_u32 s55, s55, 0x2c00
    s_add_u32 s56, s55, 10752
    v_and_b32 v13, 3, v1
    v_lshlrev_b32 v13, 7, v13
    v_lshrrev_b32 v10, 2, v1
    v_lshl_add_u32 v13, v10, 3, v13
    v_lshlrev_b32 v9, 1, v1
    s_lshl_b32 s54, s59, 4
    s_mul_i32 s57, s33, 448
    s_add_u32 s54, s54, s57
    s_lshl_b32 s54, s54, 1
    s_mov_b64 exec, 0xffff
    buffer_load_ushort v20, v9, s[48:51], s54 offen
    s_mov_b32 s96, 0
Lp_105:
    buffer_load_dwordx2 v[16:17], v13, s[36:39], s55 offen sc1
    buffer_load_dwordx2 v[18:19], v13, s[36:39], s56 offen sc1
    s_waitcnt vmcnt(0)
    v_xor_b32 v17, s32, v17
    v_xor_b32 v19, s32, v19
    v_or_b32 v17, v17, v19
    v_cmp_ne_u32 vcc, 0, v17
    s_cmp_eq_u64 vcc, 0
    s_cbranch_scc1 Lpd_106
    s_add_u32 s96, s96, 1
    s_cmp_ge_u32 s96, 0x8000
    s_cbranch_scc1 Lpd_106
    s_sleep 1
    s_branch Lp_105
Lpd_106:
    v_lshlrev_b32 v20, 16, v20
    v_lshlrev_b32 v10, 2, v1
    ds_write_b32 v10, v20 offset:1536
    ds_write_b32 v10, v16 offset:1600
    ds_write_b32 v10, v18 offset:1664
    s_mov_b64 exec, -1
L_tp_nor1:
    s_and_b32 s59, s2, 63
    s_cmp_ge_u32 s59, 56
    s_cbranch_scc1 L_tp_nocb
    s_cmp_ge_u32 s35, 2
    s_cbranch_scc1 L_tp_nocb
    s_lshr_b32 s55, s2, 6
    s_lshl_b32 s55, s55, 1
    s_add_u32 s55, s55, s35
    s_mul_i32 s55, s55, 21504
    s_add_u32 s55, s55, 0x3a00
    v_lshrrev_b32 v9, 3, v1
    v_lshlrev_b32 v9, 9, v9
    v_and_b32 v10, 7, v1
    v_lshl_add_u32 v9, v10, 4, v9
    s_add_u32 s56, s55, 3584
    s_mov_b32 exec_lo, -1
    s_mov_b32 exec_hi, 0x00ffffff
    s_mov_b32 s96, 0
Lp_107:
    buffer_load_dwordx4 v[16:19], v9, s[36:39], s55 offen offset:0 sc1
    buffer_load_dwordx4 v[20:23], v9, s[36:39], s55 offen offset:128 sc1
    buffer_load_dwordx4 v[24:27], v9, s[36:39], s55 offen offset:256 sc1
    buffer_load_dwordx4 v[28:31], v9, s[36:39], s55 offen offset:384 sc1
    buffer_load_dwordx4 v[32:35], v9, s[36:39], s56 offen offset:0 sc1
    buffer_load_dwordx4 v[36:39], v9, s[36:39], s56 offen offset:128 sc1
    buffer_load_dwordx4 v[40:43], v9, s[36:39], s56 offen offset:256 sc1
    buffer_load_dwordx4 v[44:47], v9, s[36:39], s56 offen offset:384 sc1
    s_waitcnt vmcnt(0)
    v_xor_b32 v17, s32, v17
    v_xor_b32 v19, s32, v19
    v_or_b32 v17, v17, v19
    v_xor_b32 v21, s32, v21
    v_or_b32 v17, v17, v21
    v_xor_b32 v23, s32, v23
    v_or_b32 v17, v17, v23
    v_xor_b32 v25, s32, v25
    v_or_b32 v17, v17, v25
    v_xor_b32 v27, s32, v27
    v_or_b32 v17, v17, v27
    v_xor_b32 v29, s32, v29
    v_or_b32 v17, v17, v29
    v_xor_b32 v31, s32, v31
    v_or_b32 v17, v17, v31
    v_xor_b32 v33, s32, v33
    v_or_b32 v17, v17, v33
    v_xor_b32 v35, s32, v35
    v_or_b32 v17, v17, v35
    v_xor_b32 v37, s32, v37
    v_or_b32 v17, v17, v37
    v_xor_b32 v39, s32, v39
    v_or_b32 v17, v17, v39
    v_xor_b32 v41, s32, v41
    v_or_b32 v17, v17, v41
    v_xor_b32 v43, s32, v43
    v_or_b32 v17, v17, v43
    v_xor_b32 v45, s32, v45
    v_or_b32 v17, v17, v45
    v_xor_b32 v47, s32, v47
    v_or_b32 v17, v17, v47
    v_cmp_ne_u32 vcc, 0, v17
    s_cmp_eq_u64 vcc, 0
    s_cbranch_scc1 Lpd_108
    s_add_u32 s96, s96, 1
    s_cmp_ge_u32 s96, 0x8000
    s_cbranch_scc1 Lpd_108
    s_sleep 1
    s_branch Lp_107
Lpd_108:
    v_add_f32 v32, 1.0, v32
    v_add_f32 v34, 1.0, v34
    v_cvt_pk_bf16_f32 v48, v32, v34
    v_lshlrev_b32 v32, 16, v48
    v_and_b32 v34, 0xffff0000, v48
    v_add_f32 v36, 1.0, v36
    v_add_f32 v38, 1.0, v38
    v_cvt_pk_bf16_f32 v48, v36, v38
    v_lshlrev_b32 v36, 16, v48
    v_and_b32 v38, 0xffff0000, v48
    v_add_f32 v40, 1.0, v40
    v_add_f32 v42, 1.0, v42
    v_cvt_pk_bf16_f32 v48, v40, v42
    v_lshlrev_b32 v40, 16, v48
    v_and_b32 v42, 0xffff0000, v48
    v_add_f32 v44, 1.0, v44
    v_add_f32 v46, 1.0, v46
    v_cvt_pk_bf16_f32 v48, v44, v46
    v_lshlrev_b32 v44, 16, v48
    v_and_b32 v46, 0xffff0000, v48
    v_mov_b32 v48, v32
    v_mov_b32 v56, v16
    v_mov_b32 v49, v36
    v_mov_b32 v57, v20
    v_mov_b32 v50, v40
    v_mov_b32 v58, v24
    v_mov_b32 v51, v44
    v_mov_b32 v59, v28
    v_mov_b32 v52, v34
    v_mov_b32 v60, v18
    v_mov_b32 v53, v38
    v_mov_b32 v61, v22
    v_mov_b32 v54, v42
    v_mov_b32 v62, v26
    v_mov_b32 v55, v46
    v_mov_b32 v63, v30
    s_mul_i32 s56, s35, 1792
    v_lshlrev_b32 v10, 5, v1
    v_add_u32 v10, s56, v10
    ds_write_b128 v10, v[48:51] offset:1792
    ds_write_b128 v10, v[52:55] offset:1808
    ds_write_b128 v10, v[56:59] offset:5376
    ds_write_b128 v10, v[60:63] offset:5392
    s_mov_b64 exec, -1
    s_waitcnt lgkmcnt(0)
L_tp_nocb:
    s_cmp_lg_u32 s2, 0
    s_cbranch_scc1 L_noep
    s_cmp_lg_u32 s35, 0
    s_cbranch_scc1 L_noep
    s_mov_b32 s44, s28
    s_mov_b32 s45, s29
    s_mov_b32 s46, 0x100
    s_mov_b32 s47, 0x00020000
    v_mov_b32 v8, 0
    s_mov_b32 s96, 0
L_ep:
    buffer_load_dword v9, v8, s[44:47], 0 offen sc1
    s_waitcnt vmcnt(0)
    v_readfirstlane_b32 s54, v9
    s_cmp_ge_u32 s54, 256
    s_cbranch_scc1 L_epd
    s_add_u32 s96, s96, 1
    s_cmp_ge_u32 s96, 0x8000
    s_cbranch_scc1 L_epd
    s_sleep 8
    s_branch L_ep
L_epd:
    v_mov_b32 v9, s32
    s_mov_b64 exec, 1
    buffer_store_dword v9, v8, s[36:39], 0 offen offset:0 sc1
    s_mov_b64 exec, -1
L_noep:
    s_lshr_b32 s55, s14, 1
    s_lshl_b32 s55, s55, 7
    s_add_u32 s55, s55, 0x2e0000
    v_mov_b32 v8, 0
    s_mov_b32 s56, 0
    s_lshl_b32 s59, s35, 2
    s_add_u32 s59, s59, 48
    v_mov_b32 v10, s59
L_cl:
    s_add_u32 s57, s56, 22
    s_mov_b32 s96, 0
L_clw:
    ds_read_b32 v11, v10
    s_waitcnt lgkmcnt(0)
    v_readfirstlane_b32 s54, v11
    s_cmp_ge_u32 s54, s57
    s_cbranch_scc1 L_clgo
    s_add_u32 s96, s96, 1
    s_cmp_ge_u32 s96, 0x8000
    s_cbranch_scc1 L_clgo
    s_sleep 4
    s_branch L_clw
L_clgo:
    s_mov_b32 s96, 0
L_clat:
    v_mov_b32 v12, 1
    v_mov_b32 v13, 0
    s_mov_b64 exec, 1
    buffer_atomic_add_x2 v[12:13], v8, s[36:39], s55 offen sc0 sc1
    s_waitcnt vmcnt(0)
    s_mov_b64 exec, -1
    v_readfirstlane_b32 s54, v12
    v_readfirstlane_b32 s58, v13
    s_cmp_eq_u32 s58, s32
    s_cbranch_scc1 L_clok
    s_add_u32 s96, s96, 1
    s_cmp_lt_u32 s96, 0x8000
    s_cbranch_scc1 L_clat
    s_mov_b32 s54, 64
L_clok:
    s_min_u32 s54, s54, 0xff
    s_add_u32 s58, s56, 1
    s_lshl_b32 s58, s58, 8
    s_or_b32 s58, s58, s54
    s_and_b32 s57, s56, 7
    s_lshl_b32 s57, s57, 2
    s_lshl_b32 s59, s35, 5
    s_add_u32 s57, s57, s59
    s_add_u32 s57, s57, 15104
    v_mov_b32 v14, s57
    v_mov_b32 v11, s58
    s_mov_b64 exec, 1
    ds_write_b32 v14, v11
    s_mov_b64 exec, -1
    s_add_u32 s56, s56, 1
    s_cmp_lt_u32 s54, 64
    s_cbranch_scc1 L_cl
    s_barrier
    v_and_b32 v8, 7, v1
    v_mul_u32_u24 v8, 544, v8
    v_lshrrev_b32 v10, 4, v1
    v_lshl_add_u32 v8, v10, 4, v8
    v_mov_b32 v11, 64
    ds_read_b128 v[12:15], v11
    ds_read_b128 v[16:19], v11 offset:16
    ds_read_b128 v[40:43], v8 offset:8960
    ds_read_b128 v[44:47], v8 offset:9024
    ds_read_b128 v[48:51], v8 offset:9088
    ds_read_b128 v[52:55], v8 offset:9152
    ds_read_b128 v[56:59], v8 offset:9216
    ds_read_b128 v[60:63], v8 offset:9280
    ds_read_b128 v[64:67], v8 offset:9344
    ds_read_b128 v[68:71], v8 offset:9408
    v_bfe_u32 v8, v1, 2, 2
    v_lshlrev_b32 v8, 6, v8
    v_bfe_u32 v10, v1, 4, 1
    v_lshl_add_u32 v8, v10, 5, v8
    v_and_b32 v10, 3, v1
    v_lshl_add_u32 v8, v10, 3, v8
    s_mul_i32 s54, s14, 1792
    s_lshl_b32 s55, s35, 8
    s_add_u32 s54, s54, s55
    s_add_u32 s54, s54, 0x30000
    s_waitcnt lgkmcnt(7)
    v_mfma_f32_16x16x32_bf16 v[24:27], v[40:43], v[128:131], 0
    v_mfma_f32_16x16x32_bf16 v[28:31], v[40:43], v[132:135], 0
    v_mfma_f32_16x16x32_bf16 v[32:35], v[40:43], v[136:139], 0
    v_mfma_f32_16x16x32_bf16 v[36:39], v[40:43], v[140:143], 0
    v_max3_f32 v20, v12, v14, v16
    v_max_f32 v20, v20, v18
    v_sub_f32 v12, v12, v20
    v_sub_f32 v14, v14, v20
    v_sub_f32 v16, v16, v20
    v_sub_f32 v18, v18, v20
    v_exp_f32 v12, v12
    v_exp_f32 v14, v14
    v_exp_f32 v16, v16
    v_exp_f32 v18, v18
    v_cndmask_b32 v21, v12, v16, s[52:53]
    v_cndmask_b32 v22, v14, v18, s[52:53]
    v_mov_b32 v11, s32
    s_waitcnt lgkmcnt(6)
    v_mfma_f32_16x16x32_bf16 v[24:27], v[44:47], v[144:147], v[24:27]
    v_mfma_f32_16x16x32_bf16 v[28:31], v[44:47], v[148:151], v[28:31]
    v_mfma_f32_16x16x32_bf16 v[32:35], v[44:47], v[152:155], v[32:35]
    v_mfma_f32_16x16x32_bf16 v[36:39], v[44:47], v[156:159], v[36:39]
    s_waitcnt lgkmcnt(5)
    v_mfma_f32_16x16x32_bf16 v[24:27], v[48:51], v[160:163], v[24:27]
    v_mfma_f32_16x16x32_bf16 v[28:31], v[48:51], v[164:167], v[28:31]
    v_mfma_f32_16x16x32_bf16 v[32:35], v[48:51], v[168:171], v[32:35]
    v_mfma_f32_16x16x32_bf16 v[36:39], v[48:51], v[172:175], v[36:39]
    s_waitcnt lgkmcnt(4)
    v_mfma_f32_16x16x32_bf16 v[24:27], v[52:55], v[176:179], v[24:27]
    v_mfma_f32_16x16x32_bf16 v[28:31], v[52:55], v[180:183], v[28:31]
    v_mfma_f32_16x16x32_bf16 v[32:35], v[52:55], v[184:187], v[32:35]
    v_mfma_f32_16x16x32_bf16 v[36:39], v[52:55], v[188:191], v[36:39]
    s_waitcnt lgkmcnt(3)
    v_mfma_f32_16x16x32_bf16 v[24:27], v[56:59], v[192:195], v[24:27]
    v_mfma_f32_16x16x32_bf16 v[28:31], v[56:59], v[196:199], v[28:31]
    v_mfma_f32_16x16x32_bf16 v[32:35], v[56:59], v[200:203], v[32:35]
    v_mfma_f32_16x16x32_bf16 v[36:39], v[56:59], v[204:207], v[36:39]
    s_waitcnt lgkmcnt(2)
    v_mfma_f32_16x16x32_bf16 v[24:27], v[60:63], v[208:211], v[24:27]
    v_mfma_f32_16x16x32_bf16 v[28:31], v[60:63], v[212:215], v[28:31]
    v_mfma_f32_16x16x32_bf16 v[32:35], v[60:63], v[216:219], v[32:35]
    v_mfma_f32_16x16x32_bf16 v[36:39], v[60:63], v[220:223], v[36:39]
    s_waitcnt lgkmcnt(1)
    v_mfma_f32_16x16x32_bf16 v[24:27], v[64:67], v[224:227], v[24:27]
    v_mfma_f32_16x16x32_bf16 v[28:31], v[64:67], v[228:231], v[28:31]
    v_mfma_f32_16x16x32_bf16 v[32:35], v[64:67], v[232:235], v[32:35]
    v_mfma_f32_16x16x32_bf16 v[36:39], v[64:67], v[236:239], v[36:39]
    s_waitcnt lgkmcnt(0)
    v_mfma_f32_16x16x32_bf16 v[24:27], v[68:71], v[240:243], v[24:27]
    v_mfma_f32_16x16x32_bf16 v[28:31], v[68:71], v[244:247], v[28:31]
    v_mfma_f32_16x16x32_bf16 v[32:35], v[68:71], v[248:251], v[32:35]
    v_mfma_f32_16x16x32_bf16 v[36:39], v[68:71], v[252:255], v[36:39]
    s_nop 4
    v_add_f32 v24, v24, v25
    v_add_f32 v26, v26, v27
    v_add_f32 v28, v28, v29
    v_add_f32 v30, v30, v31
    v_add_f32 v32, v32, v33
    v_add_f32 v34, v34, v35
    v_add_f32 v36, v36, v37
    v_add_f32 v38, v38, v39
    v_mul_f32 v24, v24, v21
    v_fmac_f32 v24, v26, v22
    v_mul_f32 v28, v28, v21
    v_fmac_f32 v28, v30, v22
    v_mul_f32 v32, v32, v21
    v_fmac_f32 v32, v34, v22
    v_mul_f32 v36, v36, v21
    v_fmac_f32 v36, v38, v22
    v_permlane16_swap_b32 v24, v28
    s_nop 0
    v_permlane16_swap_b32 v32, v36
    v_add_f32 v24, v24, v28
    v_add_f32 v32, v32, v36
    v_cvt_pk_bf16_f32 v10, v24, v32
    s_mov_b32 exec_hi, 0
    buffer_store_dwordx2 v[10:11], v8, s[36:39], s54 offen sc1
    s_mov_b64 exec, -1
    s_and_b32 s54, s2, 63
    s_cmp_ge_u32 s54, 56
    s_cbranch_scc1 L_fin
    v_lshlrev_b32 v8, 4, v1
    s_lshl_b32 s54, s35, 12
    s_add_u32 s54, s54, 32768
    v_add_u32 v8, s54, v8
    ds_read_b128 v[128:131], v8 offset:0
    ds_read_b128 v[132:135], v8 offset:1024
    ds_read_b128 v[136:139], v8 offset:2048
    ds_read_b128 v[140:143], v8 offset:3072
    ds_read_b128 v[144:147], v8 offset:16384
    ds_read_b128 v[148:151], v8 offset:17408
    ds_read_b128 v[152:155], v8 offset:18432
    ds_read_b128 v[156:159], v8 offset:19456
    v_bfe_u32 v9, v1, 2, 1
    v_mul_u32_u24 v9, 896, v9
    v_lshrrev_b32 v10, 4, v1
    v_lshl_add_u32 v9, v10, 4, v9
    s_lshr_b32 s55, s35, 1
    s_mul_i32 s55, s55, 448
    v_add_u32 v9, s55, v9
    s_waitcnt lgkmcnt(0)
    s_barrier
    ds_read_b128 v[40:43], v9 offset:13312
    ds_read_b128 v[44:47], v9 offset:13376
    ds_read_b128 v[48:51], v9 offset:13440
    ds_read_b128 v[52:55], v9 offset:13504
    ds_read_b128 v[56:59], v9 offset:13568
    ds_read_b128 v[60:63], v9 offset:13632
    ds_read_b128 v[64:67], v9 offset:13696
    s_waitcnt lgkmcnt(0)
    v_mfma_f32_16x16x32_bf16 v[24:27], v[40:43], v[72:75], 0
    v_mfma_f32_16x16x32_bf16 v[28:31], v[40:43], v[76:79], 0
    v_mfma_f32_16x16x32_bf16 v[24:27], v[44:47], v[80:83], v[24:27]
    v_mfma_f32_16x16x32_bf16 v[28:31], v[44:47], v[84:87], v[28:31]
    v_mfma_f32_16x16x32_bf16 v[24:27], v[48:51], v[88:91], v[24:27]
    v_mfma_f32_16x16x32_bf16 v[28:31], v[48:51], v[92:95], v[28:31]
    v_mfma_f32_16x16x32_bf16 v[24:27], v[52:55], v[96:99], v[24:27]
    v_mfma_f32_16x16x32_bf16 v[28:31], v[52:55], v[100:103], v[28:31]
    v_mfma_f32_16x16x32_bf16 v[24:27], v[56:59], v[104:107], v[24:27]
    v_mfma_f32_16x16x32_bf16 v[28:31], v[56:59], v[108:111], v[28:31]
    v_mfma_f32_16x16x32_bf16 v[24:27], v[60:63], v[112:115], v[24:27]
    v_mfma_f32_16x16x32_bf16 v[28:31], v[60:63], v[116:119], v[28:31]
    v_mfma_f32_16x16x32_bf16 v[24:27], v[64:67], v[120:123], v[24:27]
    v_mfma_f32_16x16x32_bf16 v[28:31], v[64:67], v[124:127], v[28:31]
    v_lshlrev_b32 v10, 2, v1
    s_lshl_b32 s54, s35, 8
    v_add_u32 v11, s54, v10
    s_mov_b32 exec_lo, -1
    s_mov_b32 exec_hi, 0
    s_nop 1
    ds_write_b32 v11, v24 offset:15104
    ds_write_b32 v11, v28 offset:15232
    s_mov_b64 exec, -1
    s_waitcnt lgkmcnt(0)
    s_barrier
    ds_read_b32 v32, v10 offset:15104
    ds_read_b32 v33, v10 offset:15360
    ds_read_b32 v34, v10 offset:15616
    ds_read_b32 v35, v10 offset:15872
    s_waitcnt lgkmcnt(0)
    v_add_f32 v32, v32, v34
    v_add_f32 v33, v33, v35
    v_cvt_pk_bf16_f32 v34, v32, v33
    v_lshlrev_b32 v32, 16, v34
    v_and_b32 v33, 0xffff0000, v34
    v_mul_f32 v34, v32, v32
    v_mov_b32 v36, 0x3d372713
    v_fma_f32 v34, v34, v36, 1.0
    v_mul_f32 v34, v34, v32
    v_mul_f32 v34, 0xc0135761, v34
    v_exp_f32 v34, v34
    s_nop 0
    v_add_f32 v34, 1.0, v34
    v_rcp_f32 v34, v34
    s_nop 0
    v_mul_f32 v32, v32, v34
    v_cvt_pk_bf16_f32 v34, v32, v32
    v_lshlrev_b32 v32, 16, v34
    v_mul_f32 v32, v32, v33
    v_cvt_pk_bf16_f32 v32, v32, v32
    v_and_b32 v33, 15, v1
    v_lshlrev_b32 v33, 2, v33
    v_lshrrev_b32 v34, 5, v1
    v_lshl_add_u32 v33, v34, 1, v33
    v_bfe_u32 v34, v1, 4, 1
    v_lshl_add_u32 v33, v34, 6, v33
    s_lshl_b32 s54, s35, 7
    s_add_u32 s54, s54, 16128
    v_add_u32 v33, s54, v33
    ds_write_b16 v33, v32
    v_bfe_u32 v34, v1, 2, 1
    v_lshlrev_b32 v34, 6, v34
    v_lshrrev_b32 v35, 4, v1
    v_lshl_add_u32 v34, v35, 4, v34
    v_add_u32 v34, s54, v34
    s_waitcnt lgkmcnt(0)
    ds_read_b128 v[40:43], v34
    s_waitcnt lgkmcnt(0)
    v_mfma_f32_16x16x32_bf16 v[160:163], v[40:43], v[128:131], 0
    v_mfma_f32_16x16x32_bf16 v[164:167], v[40:43], v[132:135], 0
    v_mfma_f32_16x16x32_bf16 v[168:171], v[40:43], v[136:139], 0
    v_mfma_f32_16x16x32_bf16 v[172:175], v[40:43], v[140:143], 0
    v_mfma_f32_16x16x32_bf16 v[176:179], v[40:43], v[144:147], 0
    v_mfma_f32_16x16x32_bf16 v[180:183], v[40:43], v[148:151], 0
    v_mfma_f32_16x16x32_bf16 v[184:187], v[40:43], v[152:155], 0
    v_mfma_f32_16x16x32_bf16 v[188:191], v[40:43], v[156:159], 0
    v_bfe_u32 v33, v1, 4, 1
    v_mul_u32_u24 v33, 1792, v33
    v_lshrrev_b32 v34, 5, v1
    v_lshl_add_u32 v33, v34, 5, v33
    v_bfe_u32 v34, v1, 2, 2
    v_lshl_add_u32 v33, v34, 6, v33
    v_and_b32 v34, 3, v1
    v_lshl_add_u32 v33, v34, 3, v33
    s_lshr_b32 s54, s2, 6
    s_mul_i32 s54, s54, 56
    s_and_b32 s55, s2, 63
    s_add_u32 s54, s54, s55
    s_mul_i32 s54, s54, 3584
    s_lshl_b32 s55, s35, 8
    s_add_u32 s54, s54, s55
    s_add_u32 s54, s54, 0x120000
    v_mov_b32 v37, s32
    v_mov_b32 v39, s32
    v_cvt_pk_bf16_f32 v36, v160, v168
    v_cvt_pk_bf16_f32 v35, v164, v172
    s_nop 1
    v_mov_b32_dpp v36, v35 quad_perm:[0,1,2,3] row_mask:0xc bank_mask:0xf
    buffer_store_dwordx2 v[36:37], v33, s[36:39], s54 offen offset:0 sc1
    s_cmp_eq_u32 s35, 3
    s_cbranch_scc1 L_fdone
    v_cvt_pk_bf16_f32 v38, v176, v184
    v_cvt_pk_bf16_f32 v35, v180, v188
    s_nop 1
    v_mov_b32_dpp v38, v35 quad_perm:[0,1,2,3] row_mask:0xc bank_mask:0xf
    buffer_store_dwordx2 v[38:39], v33, s[36:39], s54 offen offset:1024 sc1
L_fdone:
    s_waitcnt vmcnt(0)
    s_waitcnt lgkmcnt(0)
    v_mov_b32 v33, 44
    v_mov_b32 v34, 1
    s_mov_b64 exec, 1
    ds_add_u32 v33, v34
    s_mov_b64 exec, -1
L_fin:
L_end:
    s_endpgm
.section .rodata,"a"
.p2align 6
.amdhsa_kernel adaLN_cond__mha_block_cached__geglu_ffn__decode_kernel
  .amdhsa_next_free_vgpr 256
  .amdhsa_next_free_sgpr 102
  .amdhsa_accum_offset 256
  .amdhsa_group_segment_fixed_size 0
  .amdhsa_kernarg_size 112
  .amdhsa_user_sgpr_count 2
  .amdhsa_user_sgpr_kernarg_segment_ptr 1
  .amdhsa_system_sgpr_workgroup_id_x 1
  .amdhsa_float_denorm_mode_32 3
.end_amdhsa_kernel
```
